```python
import torch

def _softmax(x, axis=-1):
    return torch.softmax(x, dim=axis)
def _gelu(x):
    return torch.nn.functional.gelu(x, approximate="tanh")
def _silu(x):
    return torch.nn.functional.silu(x)
def _sigmoid(x):
    return torch.sigmoid(x)
def _layernorm(x, axis=-1, eps=1e-5):
    m = x.mean(dim=axis, keepdim=True)
    v = x.var(dim=axis, keepdim=True, unbiased=False)
    return (x - m) / torch.sqrt(v + eps)
def _scatter_add(tgt, idx, src, axis=0):
    return tgt.clone().index_add_(axis, idx, src)
def _segment_sum(src, seg, n):
    out = torch.zeros((n,) + src.shape[1:], dtype=src.dtype)
    return out.index_add_(0, seg, src)
def _pad(x, pw):
    flat = tuple(v for pair in reversed(pw) for v in pair)
    return torch.nn.functional.pad(x, flat)

kernel_name = 'recurrent_scan__spectral_gfnet__dense_activation_silu__prompt'

def setup_inputs():

    _w = (lambda a: (lambda t: t.to(torch.bfloat16) if t.is_floating_point() else t)(torch.as_tensor(a)))
    def _A_setup():
        B, S, D = 1, 2048, 512
        Df = D // 2 + 1
        return {
            "x": _w((lambda *s: torch.randn(*s, dtype=torch.bfloat16) * 0.05)(B, S, D)),
            "w_r": _w((lambda *s: torch.randn(*s, dtype=torch.bfloat16) * 3.2)(S, Df) * 0.02),
            "w_i": _w((lambda *s: torch.randn(*s, dtype=torch.bfloat16) * 3.2)(S, Df) * 0.02),
        }
    _A_in = _A_setup()

    def _B_setup():
        B, S, D, F = 1, 2048, 512, 1792
        return {
            "x": _w((lambda *s: torch.randn(*s, dtype=torch.bfloat16) * 0.05)(B, S, D)),
            "w1": _w((lambda *s: torch.randn(*s, dtype=torch.bfloat16) * 3.2)(D, F) * (D ** -0.5)),
            "w2": _w((lambda *s: torch.randn(*s, dtype=torch.bfloat16) * 0.4)(F, D) * (F ** -0.5)),
        }
    _B_in = _B_setup()

    return {
        "A_x": _A_in["x"],
        "A_w_r": _A_in["w_r"],
        "A_w_i": _A_in["w_i"],
        "B_x": _B_in["x"],
        "B_w1": _B_in["w1"],
        "B_w2": _B_in["w2"],
    }

def reference(A_x, A_w_r, A_w_i, B_x, B_w1, B_w2):
    def _A_ref(x, w_r, w_i):
        B, S, D = x.shape
        X = (lambda x, axes=(-2,-1): torch.fft.rfft2(x.float(), dim=axes))(x, axes=(-2, -1))
        W = w_r + 1j * w_i
        X = X * W
        y = (lambda x, s, axes=(-2,-1): torch.fft.irfft2(x, s=s, dim=axes).to(torch.bfloat16))(X, (S, D), axes=(-2, -1))
        return y

    def _B_ref(x, w1, w2):
        h = torch.einsum("bsd,df->bsf", x, w1)
        h = _silu(h)
        out = torch.einsum("bsf,fd->bsd", h, w2)
        return out

    x = A_x
    xn = _layernorm(x, axis=-1)
    s = _A_ref(xn, A_w_r, A_w_i)
    g = _silu(_B_ref(xn, B_w1, B_w2))
    return x + s * g
```

```asm
; @launch kernel=k1_kernel grid=(256,1,1) block=(512,1,1) lds=163840
; @launch kernel=k2_kernel grid=(256,1,1) block=(512,1,1) lds=139328
; @launch kernel=k3_kernel grid=(256,1,1) block=(512,1,1) lds=86016
.amdgcn_target "amdgcn-amd-amdhsa--gfx950"
.text
.globl k1_kernel
.p2align 8
.type k1_kernel,@function
k1_kernel:
    s_cmpk_ge_u32 s2, 256
    s_cbranch_scc1 END_k1_kernel
    s_load_dwordx2 s[24:25], s[0:1], 0
    s_load_dwordx2 s[28:29], s[0:1], 32
    s_load_dwordx2 s[36:37], s[0:1], 64
    s_load_dwordx2 s[44:45], s[0:1], 8
    s_load_dwordx2 s[48:49], s[0:1], 16
    s_load_dwordx2 s[40:41], s[0:1], 40
    v_lshrrev_b32 v4, 6, v0
    v_and_b32 v1, 63, v0
    v_readfirstlane_b32 s3, v4
    v_lshrrev_b32 v2, 4, v1
    v_and_b32 v3, 15, v0
    v_and_b32 v21, 3, v0
    v_lshlrev_b32 v46, 4, v1
    s_lshr_b32 s59, s2, 6
    s_bfe_u32 s58, s2, 0x20001
    s_lshl2_add_u32 s58, s58, s59
    s_bfe_u32 s60, s2, 0x30003
    s_and_b32 s56, s2, 1
    s_mov_b32 s38, 0x1200000
    s_mov_b32 s39, 0x20000
    s_and_b32 s55, s3, 3
    s_cmp_lt_u32 s3, 4
    s_cbranch_scc1 K1_MMA
    s_cmp_ge_u32 s3, 6
    s_cbranch_scc1 K1_STAT
    s_setprio 0
    s_and_b32 s54, s3, 1
    v_and_b32 v22, 7, v0
    v_and_b32 v23, 24, v0
    v_lshlrev_b32 v20, 13, v23
    v_and_b32 v23, 32, v0
    v_lshl_or_b32 v20, v23, 5, v20
    v_xor_b32 v23, v22, v2
    v_lshl_or_b32 v4, v23, 4, v20
    v_xor_b32 v5, 64, v4
    v_add_u32 v5, 0x400, v5
    v_add_u32 v6, 0xff800, v4
    v_add_u32 v7, 0xff800, v5
    s_lshl_b32 s81, s58, 12
    s_lshl_b32 s63, s54, 19
    s_add_u32 s81, s81, s63
    s_mov_b32 s26, 0x200000
    s_mov_b32 s27, 0x20000
    s_mov_b32 s31, 0x20000
    s_lshl_b32 s73, s54, 13
    s_movk_i32 s57, 0x3ff
    s_cmp_eq_u32 s60, 7
    s_cbranch_scc1 K1_LF
    v_lshrrev_b32 v27, 3, v1
    v_mul_u32_u24 v40, 0xe00, v27
    v_lshrrev_b32 v26, 3, v0
    v_and_b32 v26, 2, v26
    v_xor_b32 v26, v22, v26
    v_lshl_add_u32 v40, v26, 4, v40
    v_add_u32 v41, 113664, v40
    v_xor_b32 v42, 64, v40
    v_add_u32 v42, 26624, v42
    v_add_u32 v43, 113664, v42
    s_add_u32 s76, s59, s60
    s_and_b32 s76, s76, 1
    s_lshl_b32 s76, s76, 8
    s_mul_i32 s70, s56, 7
    s_add_u32 s70, s60, s70
    s_lshl1_add_u32 s70, s70, s54
    s_lshl_b32 s70, s70, 7
    s_mov_b32 s30, 1835008
    s_waitcnt lgkmcnt(0)
    s_mov_b32 s77, s76
    s_movk_i32 s72, 0x3ff
    s_add_u32 s83, s76, s81
    s_add_u32 m0, s73, 0
    s_addk_i32 s76, 128
    buffer_load_dwordx4 v4, s[24:27], s83 offen offset:0 lds
    buffer_load_dwordx4 v5, s[24:27], s83 offen offset:1024 lds
    buffer_load_dwordx4 v6, s[24:27], s83 offen offset:2048 lds
    buffer_load_dwordx4 v7, s[24:27], s83 offen offset:3072 lds
    s_add_u32 m0, s73, 4096
    s_add_u32 s83, s83, 0x40000
    buffer_load_dwordx4 v4, s[24:27], s83 offen offset:0 lds
    buffer_load_dwordx4 v5, s[24:27], s83 offen offset:1024 lds
    buffer_load_dwordx4 v6, s[24:27], s83 offen offset:2048 lds
    buffer_load_dwordx4 v7, s[24:27], s83 offen offset:3072 lds
    s_and_b32 s76, s76, s57
    s_mul_i32 s79, s77, 1792
    s_add_u32 m0, s73, 16384
    s_add_u32 s79, s79, s70
    s_addk_i32 s77, 128
    buffer_load_dwordx4 v40, s[28:31], s79 offen offset:0 lds
    buffer_load_dwordx4 v41, s[28:31], s79 offen offset:1024 lds
    buffer_load_dwordx4 v42, s[28:31], s79 offen offset:2048 lds
    buffer_load_dwordx4 v43, s[28:31], s79 offen offset:3072 lds
    s_add_u32 m0, s73, 20480
    s_add_u32 s79, s79, 57344
    buffer_load_dwordx4 v40, s[28:31], s79 offen offset:0 lds
    buffer_load_dwordx4 v41, s[28:31], s79 offen offset:1024 lds
    buffer_load_dwordx4 v42, s[28:31], s79 offen offset:2048 lds
    buffer_load_dwordx4 v43, s[28:31], s79 offen offset:3072 lds
    s_and_b32 s77, s77, s72
    s_add_u32 s83, s76, s81
    s_add_u32 m0, s73, 32768
    s_addk_i32 s76, 128
    buffer_load_dwordx4 v4, s[24:27], s83 offen offset:0 lds
    buffer_load_dwordx4 v5, s[24:27], s83 offen offset:1024 lds
    buffer_load_dwordx4 v6, s[24:27], s83 offen offset:2048 lds
    buffer_load_dwordx4 v7, s[24:27], s83 offen offset:3072 lds
    s_add_u32 m0, s73, 36864
    s_add_u32 s83, s83, 0x40000
    buffer_load_dwordx4 v4, s[24:27], s83 offen offset:0 lds
    buffer_load_dwordx4 v5, s[24:27], s83 offen offset:1024 lds
    buffer_load_dwordx4 v6, s[24:27], s83 offen offset:2048 lds
    buffer_load_dwordx4 v7, s[24:27], s83 offen offset:3072 lds
    s_and_b32 s76, s76, s57
    s_mul_i32 s79, s77, 1792
    s_add_u32 m0, s73, 49152
    s_add_u32 s79, s79, s70
    s_addk_i32 s77, 128
    buffer_load_dwordx4 v40, s[28:31], s79 offen offset:0 lds
    buffer_load_dwordx4 v41, s[28:31], s79 offen offset:1024 lds
    buffer_load_dwordx4 v42, s[28:31], s79 offen offset:2048 lds
    buffer_load_dwordx4 v43, s[28:31], s79 offen offset:3072 lds
    s_add_u32 m0, s73, 53248
    s_add_u32 s79, s79, 57344
    buffer_load_dwordx4 v40, s[28:31], s79 offen offset:0 lds
    buffer_load_dwordx4 v41, s[28:31], s79 offen offset:1024 lds
    buffer_load_dwordx4 v42, s[28:31], s79 offen offset:2048 lds
    buffer_load_dwordx4 v43, s[28:31], s79 offen offset:3072 lds
    s_and_b32 s77, s77, s72
    s_mul_i32 s71, s59, 7
    s_add_u32 s71, s71, s60
    s_and_b32 s63, s2, 7
    s_lshl3_add_u32 s71, s71, s63
    s_mov_b32 s75, s2
    s_waitcnt vmcnt(16)
    s_barrier
    s_add_u32 s83, s76, s81
    s_add_u32 m0, s73, 65536
    s_addk_i32 s76, 128
    buffer_load_dwordx4 v4, s[24:27], s83 offen offset:0 lds
    buffer_load_dwordx4 v5, s[24:27], s83 offen offset:1024 lds
    buffer_load_dwordx4 v6, s[24:27], s83 offen offset:2048 lds
    buffer_load_dwordx4 v7, s[24:27], s83 offen offset:3072 lds
    s_add_u32 m0, s73, 69632
    s_add_u32 s83, s83, 0x40000
    buffer_load_dwordx4 v4, s[24:27], s83 offen offset:0 lds
    buffer_load_dwordx4 v5, s[24:27], s83 offen offset:1024 lds
    buffer_load_dwordx4 v6, s[24:27], s83 offen offset:2048 lds
    buffer_load_dwordx4 v7, s[24:27], s83 offen offset:3072 lds
    s_and_b32 s76, s76, s57
    s_mul_i32 s79, s77, 1792
    s_add_u32 m0, s73, 81920
    s_add_u32 s79, s79, s70
    s_addk_i32 s77, 128
    buffer_load_dwordx4 v40, s[28:31], s79 offen offset:0 lds
    buffer_load_dwordx4 v41, s[28:31], s79 offen offset:1024 lds
    buffer_load_dwordx4 v42, s[28:31], s79 offen offset:2048 lds
    buffer_load_dwordx4 v43, s[28:31], s79 offen offset:3072 lds
    s_add_u32 m0, s73, 86016
    s_add_u32 s79, s79, 57344
    buffer_load_dwordx4 v40, s[28:31], s79 offen offset:0 lds
    buffer_load_dwordx4 v41, s[28:31], s79 offen offset:1024 lds
    buffer_load_dwordx4 v42, s[28:31], s79 offen offset:2048 lds
    buffer_load_dwordx4 v43, s[28:31], s79 offen offset:3072 lds
    s_and_b32 s77, s77, s72
    s_waitcnt vmcnt(16)
    s_barrier
    s_add_u32 s83, s76, s81
    s_add_u32 m0, s73, 98304
    s_addk_i32 s76, 128
    buffer_load_dwordx4 v4, s[24:27], s83 offen offset:0 lds
    buffer_load_dwordx4 v5, s[24:27], s83 offen offset:1024 lds
    buffer_load_dwordx4 v6, s[24:27], s83 offen offset:2048 lds
    buffer_load_dwordx4 v7, s[24:27], s83 offen offset:3072 lds
    s_add_u32 m0, s73, 102400
    s_add_u32 s83, s83, 0x40000
    buffer_load_dwordx4 v4, s[24:27], s83 offen offset:0 lds
    buffer_load_dwordx4 v5, s[24:27], s83 offen offset:1024 lds
    buffer_load_dwordx4 v6, s[24:27], s83 offen offset:2048 lds
    buffer_load_dwordx4 v7, s[24:27], s83 offen offset:3072 lds
    s_and_b32 s76, s76, s57
    s_mul_i32 s79, s77, 1792
    s_add_u32 m0, s73, 114688
    s_add_u32 s79, s79, s70
    s_addk_i32 s77, 128
    buffer_load_dwordx4 v40, s[28:31], s79 offen offset:0 lds
    buffer_load_dwordx4 v41, s[28:31], s79 offen offset:1024 lds
    buffer_load_dwordx4 v42, s[28:31], s79 offen offset:2048 lds
    buffer_load_dwordx4 v43, s[28:31], s79 offen offset:3072 lds
    s_add_u32 m0, s73, 118784
    s_add_u32 s79, s79, 57344
    buffer_load_dwordx4 v40, s[28:31], s79 offen offset:0 lds
    buffer_load_dwordx4 v41, s[28:31], s79 offen offset:1024 lds
    buffer_load_dwordx4 v42, s[28:31], s79 offen offset:2048 lds
    buffer_load_dwordx4 v43, s[28:31], s79 offen offset:3072 lds
    s_and_b32 s77, s77, s72
    s_add_u32 s83, s76, s81
    s_add_u32 m0, s73, 0
    s_addk_i32 s76, 128
    buffer_load_dwordx4 v4, s[24:27], s83 offen offset:0 lds
    buffer_load_dwordx4 v5, s[24:27], s83 offen offset:1024 lds
    buffer_load_dwordx4 v6, s[24:27], s83 offen offset:2048 lds
    buffer_load_dwordx4 v7, s[24:27], s83 offen offset:3072 lds
    s_add_u32 m0, s73, 4096
    s_add_u32 s83, s83, 0x40000
    buffer_load_dwordx4 v4, s[24:27], s83 offen offset:0 lds
    buffer_load_dwordx4 v5, s[24:27], s83 offen offset:1024 lds
    buffer_load_dwordx4 v6, s[24:27], s83 offen offset:2048 lds
    buffer_load_dwordx4 v7, s[24:27], s83 offen offset:3072 lds
    s_and_b32 s76, s76, s57
    s_mul_i32 s79, s77, 1792
    s_add_u32 m0, s73, 16384
    s_add_u32 s79, s79, s70
    s_addk_i32 s77, 128
    buffer_load_dwordx4 v40, s[28:31], s79 offen offset:0 lds
    buffer_load_dwordx4 v41, s[28:31], s79 offen offset:1024 lds
    buffer_load_dwordx4 v42, s[28:31], s79 offen offset:2048 lds
    buffer_load_dwordx4 v43, s[28:31], s79 offen offset:3072 lds
    s_add_u32 m0, s73, 20480
    s_add_u32 s79, s79, 57344
    buffer_load_dwordx4 v40, s[28:31], s79 offen offset:0 lds
    buffer_load_dwordx4 v41, s[28:31], s79 offen offset:1024 lds
    buffer_load_dwordx4 v42, s[28:31], s79 offen offset:2048 lds
    buffer_load_dwordx4 v43, s[28:31], s79 offen offset:3072 lds
    s_and_b32 s77, s77, s72
    s_waitcnt vmcnt(32)
    s_barrier
    s_add_u32 s83, s76, s81
    s_add_u32 m0, s73, 32768
    s_addk_i32 s76, 128
    buffer_load_dwordx4 v4, s[24:27], s83 offen offset:0 lds
    buffer_load_dwordx4 v5, s[24:27], s83 offen offset:1024 lds
    buffer_load_dwordx4 v6, s[24:27], s83 offen offset:2048 lds
    buffer_load_dwordx4 v7, s[24:27], s83 offen offset:3072 lds
    s_add_u32 m0, s73, 36864
    s_add_u32 s83, s83, 0x40000
    buffer_load_dwordx4 v4, s[24:27], s83 offen offset:0 lds
    buffer_load_dwordx4 v5, s[24:27], s83 offen offset:1024 lds
    buffer_load_dwordx4 v6, s[24:27], s83 offen offset:2048 lds
    buffer_load_dwordx4 v7, s[24:27], s83 offen offset:3072 lds
    s_and_b32 s76, s76, s57
    s_mul_i32 s79, s77, 1792
    s_add_u32 m0, s73, 49152
    s_add_u32 s79, s79, s70
    s_addk_i32 s77, 128
    buffer_load_dwordx4 v40, s[28:31], s79 offen offset:0 lds
    buffer_load_dwordx4 v41, s[28:31], s79 offen offset:1024 lds
    buffer_load_dwordx4 v42, s[28:31], s79 offen offset:2048 lds
    buffer_load_dwordx4 v43, s[28:31], s79 offen offset:3072 lds
    s_add_u32 m0, s73, 53248
    s_add_u32 s79, s79, 57344
    buffer_load_dwordx4 v40, s[28:31], s79 offen offset:0 lds
    buffer_load_dwordx4 v41, s[28:31], s79 offen offset:1024 lds
    buffer_load_dwordx4 v42, s[28:31], s79 offen offset:2048 lds
    buffer_load_dwordx4 v43, s[28:31], s79 offen offset:3072 lds
    s_and_b32 s77, s77, s72
    s_and_b32 s62, s54, 1
    s_lshl1_add_u32 s63, s75, s62
    s_and_b32 s69, s63, 7
    s_lshr_b32 s63, s63, 3
    s_lshl_b32 s63, s63, 1
    s_and_b32 s64, s63, 3
    s_and_b32 s65, s63, 12
    s_lshl4_add_u32 s64, s65, s64
    s_and_b32 s65, s63, 32
    s_lshl3_add_u32 s64, s65, s64
    s_lshr_b32 s65, s63, 6
    s_lshl3_add_u32 s64, s65, s64
    s_and_b32 s65, s63, 16
    s_lshl2_add_u32 s64, s64, s65
    s_mulk_i32 s64, 257
    s_lshl4_add_u32 s64, s69, s64
    s_lshl4_add_u32 s64, s69, s64
    s_lshl_b32 s64, s64, 1
    s_add_u32 s64, s64, 2
    s_lshl_b32 s69, s69, 12
    s_add_u32 s69, s69, s63
    s_lshl_b32 s69, s69, 6
    s_add_u32 s84, s69, 10485760
    s_mov_b32 s46, 1052672
    s_mov_b32 s47, 0x20000
    s_mov_b32 s50, 1052672
    s_mov_b32 s51, 0x20000
    s_mul_i32 s53, s54, 0x1800
    s_add_u32 s53, s53, 133120
    s_cmp_ge_u32 s54, 2
    s_cselect_b32 s63, 6144, 0
    s_add_u32 s53, s53, s63
    v_bfe_u32 v24, v0, 2, 2
    v_lshl_add_u32 v32, v24, 6, v2
    v_mul_u32_u24 v32, 514, v32
    v_lshl_add_u32 v32, v21, 4, v32
    v_lshrrev_b32 v12, 2, v1
    v_add_u32 v39, s53, v46
    v_lshlrev_b32 v37, 6, v12
    v_lshl_add_u32 v37, v21, 3, v37
    v_add_u32 v37, s53, v37
    v_lshlrev_b32 v27, 4, v2
    v_lshl_add_u32 v27, v3, 7, v27
    v_add_u32 v27, s53, v27
    v_lshrrev_b32 v36, 3, v1
    v_lshlrev_b32 v36, 13, v36
    v_lshl_add_u32 v36, v22, 4, v36
    s_lshr_b32 s65, s71, 2
    s_and_b32 s66, s71, 3
    s_lshl1_add_u32 s67, s66, s62
    s_lshl_b32 s67, s67, 7
    s_lshl_b32 s63, s65, 15
    s_add_u32 s67, s67, s63
    s_mul_i32 s66, s66, 56
    s_add_u32 s66, s66, s65
    s_lshl1_add_u32 s66, s66, s62
    s_lshl_b32 s66, s66, 12
    s_add_u32 s86, s66, 16777216
    s_add_u32 s65, s67, 0x4000
    s_mov_b32 s42, 1835008
    s_mov_b32 s43, 0x20000
    v_lshlrev_b32 v33, 10, v12
    v_lshl_add_u32 v33, v21, 4, v33
    v_lshl_add_u32 v38, v2, 8, v37
    s_waitcnt vmcnt(32)
    s_barrier
    s_add_u32 s83, s76, s81
    s_add_u32 m0, s73, 65536
    s_addk_i32 s76, 128
    buffer_load_dwordx4 v4, s[24:27], s83 offen offset:0 lds
    buffer_load_dwordx4 v5, s[24:27], s83 offen offset:1024 lds
    buffer_load_dwordx4 v6, s[24:27], s83 offen offset:2048 lds
    buffer_load_dwordx4 v7, s[24:27], s83 offen offset:3072 lds
    s_add_u32 m0, s73, 69632
    s_add_u32 s83, s83, 0x40000
    buffer_load_dwordx4 v4, s[24:27], s83 offen offset:0 lds
    buffer_load_dwordx4 v5, s[24:27], s83 offen offset:1024 lds
    buffer_load_dwordx4 v6, s[24:27], s83 offen offset:2048 lds
    buffer_load_dwordx4 v7, s[24:27], s83 offen offset:3072 lds
    s_and_b32 s76, s76, s57
    s_mul_i32 s79, s77, 1792
    s_add_u32 m0, s73, 81920
    s_add_u32 s79, s79, s70
    s_addk_i32 s77, 128
    buffer_load_dwordx4 v40, s[28:31], s79 offen offset:0 lds
    buffer_load_dwordx4 v41, s[28:31], s79 offen offset:1024 lds
    buffer_load_dwordx4 v42, s[28:31], s79 offen offset:2048 lds
    buffer_load_dwordx4 v43, s[28:31], s79 offen offset:3072 lds
    s_add_u32 m0, s73, 86016
    s_add_u32 s79, s79, 57344
    buffer_load_dwordx4 v40, s[28:31], s79 offen offset:0 lds
    buffer_load_dwordx4 v41, s[28:31], s79 offen offset:1024 lds
    buffer_load_dwordx4 v42, s[28:31], s79 offen offset:2048 lds
    buffer_load_dwordx4 v43, s[28:31], s79 offen offset:3072 lds
    s_and_b32 s77, s77, s72
    s_waitcnt vmcnt(32)
    s_barrier
    s_add_u32 s83, s76, s81
    s_add_u32 m0, s73, 98304
    s_addk_i32 s76, 128
    buffer_load_dwordx4 v4, s[24:27], s83 offen offset:0 lds
    buffer_load_dwordx4 v5, s[24:27], s83 offen offset:1024 lds
    buffer_load_dwordx4 v6, s[24:27], s83 offen offset:2048 lds
    buffer_load_dwordx4 v7, s[24:27], s83 offen offset:3072 lds
    s_add_u32 m0, s73, 102400
    s_add_u32 s83, s83, 0x40000
    buffer_load_dwordx4 v4, s[24:27], s83 offen offset:0 lds
    buffer_load_dwordx4 v5, s[24:27], s83 offen offset:1024 lds
    buffer_load_dwordx4 v6, s[24:27], s83 offen offset:2048 lds
    buffer_load_dwordx4 v7, s[24:27], s83 offen offset:3072 lds
    s_and_b32 s76, s76, s57
    s_mul_i32 s79, s77, 1792
    s_add_u32 m0, s73, 114688
    s_add_u32 s79, s79, s70
    s_addk_i32 s77, 128
    buffer_load_dwordx4 v40, s[28:31], s79 offen offset:0 lds
    buffer_load_dwordx4 v41, s[28:31], s79 offen offset:1024 lds
    buffer_load_dwordx4 v42, s[28:31], s79 offen offset:2048 lds
    buffer_load_dwordx4 v43, s[28:31], s79 offen offset:3072 lds
    s_add_u32 m0, s73, 118784
    s_add_u32 s79, s79, 57344
    buffer_load_dwordx4 v40, s[28:31], s79 offen offset:0 lds
    buffer_load_dwordx4 v41, s[28:31], s79 offen offset:1024 lds
    buffer_load_dwordx4 v42, s[28:31], s79 offen offset:2048 lds
    buffer_load_dwordx4 v43, s[28:31], s79 offen offset:3072 lds
    s_and_b32 s77, s77, s72
    buffer_load_dwordx4 v[52:55], v32, s[44:47], s64 offen offset:0
    buffer_load_dwordx4 v[56:59], v32, s[48:51], s64 offen offset:0
    buffer_load_dwordx4 v[60:63], v33, s[40:43], s67 offen offset:0
    buffer_load_dwordx4 v[64:67], v33, s[40:43], s65 offen offset:0
    buffer_load_dwordx4 v[68:71], v32, s[44:47], s64 offen offset:2056
    buffer_load_dwordx4 v[72:75], v32, s[48:51], s64 offen offset:2056
    buffer_load_dwordx4 v[76:79], v33, s[40:43], s67 offen offset:64
    buffer_load_dwordx4 v[80:83], v33, s[40:43], s65 offen offset:64
    s_getpc_b64 s[22:23]
PC1_k1_kernel:
    s_and_b32 s63, s2, 0xf8
    v_min_u32 v26, 7, v1
    v_add_lshl_u32 v26, v26, s63, 7
    s_add_u32 s22, s22, k2_kernel-PC1_k1_kernel
    s_addc_u32 s23, s23, 0
    v_min_u32 v26, CODE_END-k2_kernel-4, v26
    global_load_dword v8, v26, s[22:23]
    s_getpc_b64 s[22:23]
    s_add_u32 s22, s22, CTAB@rel32@lo+4
    s_addc_u32 s23, s23, CTAB@rel32@hi+12
    s_lshr_b32 s63, s63, 1
    v_add_lshl_u32 v26, v21, s63, 7
    global_load_dword v9, v26, s[22:23]
    s_waitcnt vmcnt(42)
    s_barrier
    s_waitcnt vmcnt(26)
    s_barrier
    s_waitcnt vmcnt(10)
    s_barrier
    s_barrier
    s_barrier
    s_waitcnt vmcnt(9)
    ds_write_b128 v39, v[52:55] offset:0
    s_waitcnt vmcnt(8)
    ds_write_b128 v39, v[56:59] offset:1024
    ds_read_b64_tr_b16 v[52:53], v37 offset:0
    ds_read_b64_tr_b16 v[54:55], v37 offset:1024
    ds_read_b64_tr_b16 v[56:57], v37 offset:32
    ds_read_b64_tr_b16 v[58:59], v37 offset:1056
    s_waitcnt vmcnt(7)
    ds_write_b128 v39, v[60:63] offset:0
    s_waitcnt vmcnt(6)
    ds_write_b128 v39, v[64:67] offset:1024
    ds_read_b64_tr_b16 v[60:61], v38 offset:0
    ds_read_b64_tr_b16 v[62:63], v38 offset:256
    ds_read_b64_tr_b16 v[64:65], v38 offset:32
    ds_read_b64_tr_b16 v[66:67], v38 offset:288
    s_waitcnt lgkmcnt(8)
    ds_write_b128 v27, v[52:55] offset:2048
    s_waitcnt lgkmcnt(7)
    ds_write_b128 v27, v[56:59] offset:4096
    s_waitcnt lgkmcnt(4)
    buffer_store_dwordx4 v[60:63], v46, s[36:39], s86 offen offset:0 sc1
    s_waitcnt lgkmcnt(2)
    buffer_store_dwordx4 v[64:67], v46, s[36:39], s86 offen offset:1024 sc1
    s_waitcnt vmcnt(7)
    ds_write_b128 v39, v[68:71] offset:0
    s_waitcnt vmcnt(6)
    ds_write_b128 v39, v[72:75] offset:1024
    ds_read_b64_tr_b16 v[68:69], v37 offset:0
    ds_read_b64_tr_b16 v[70:71], v37 offset:1024
    ds_read_b64_tr_b16 v[72:73], v37 offset:32
    ds_read_b64_tr_b16 v[74:75], v37 offset:1056
    s_waitcnt vmcnt(5)
    ds_write_b128 v39, v[76:79] offset:0
    s_waitcnt vmcnt(4)
    ds_write_b128 v39, v[80:83] offset:1024
    ds_read_b64_tr_b16 v[76:77], v38 offset:0
    ds_read_b64_tr_b16 v[78:79], v38 offset:256
    ds_read_b64_tr_b16 v[80:81], v38 offset:32
    ds_read_b64_tr_b16 v[82:83], v38 offset:288
    s_waitcnt lgkmcnt(8)
    ds_write_b128 v27, v[68:71] offset:2112
    s_waitcnt lgkmcnt(7)
    ds_write_b128 v27, v[72:75] offset:4160
    s_waitcnt lgkmcnt(4)
    buffer_store_dwordx4 v[76:79], v46, s[36:39], s86 offen offset:2048 sc1
    s_waitcnt lgkmcnt(2)
    buffer_store_dwordx4 v[80:83], v46, s[36:39], s86 offen offset:3072 sc1
    ds_read_b128 v[84:87], v39 offset:2048
    ds_read_b128 v[88:91], v39 offset:3072
    ds_read_b128 v[92:95], v39 offset:4096
    ds_read_b128 v[96:99], v39 offset:5120
    s_waitcnt lgkmcnt(3)
    buffer_store_dwordx4 v[84:87], v36, s[36:39], s84 offen sc1
    s_add_u32 s84, s84, 0x10000
    s_waitcnt lgkmcnt(2)
    buffer_store_dwordx4 v[88:91], v36, s[36:39], s84 offen sc1
    s_add_u32 s84, s84, 0x10000
    s_waitcnt lgkmcnt(1)
    buffer_store_dwordx4 v[92:95], v36, s[36:39], s84 offen sc1
    s_add_u32 s84, s84, 0x10000
    s_waitcnt lgkmcnt(0)
    buffer_store_dwordx4 v[96:99], v36, s[36:39], s84 offen sc1
    s_endpgm
K1_LF:
    s_lshl_b32 s70, s56, 17
    s_add_u32 s70, s70, s73
    s_waitcnt lgkmcnt(0)
    s_getpc_b64 s[28:29]
    s_add_u32 s28, s28, FB2@rel32@lo+4
    s_addc_u32 s29, s29, FB2@rel32@hi+12
    s_mov_b32 s30, 0x40000
    s_and_b32 s76, s59, 3
    s_lshl_b32 s77, s76, 8
    s_lshl_b32 s76, s76, 7
    s_movk_i32 s72, 0x3ff
    s_movk_i32 s57, 0x1ff
    s_add_u32 s83, s76, s81
    s_add_u32 m0, s73, 0
    s_nop 0
    buffer_load_dwordx4 v4, s[24:27], s83 offen offset:0 lds
    buffer_load_dwordx4 v5, s[24:27], s83 offen offset:1024 lds
    buffer_load_dwordx4 v6, s[24:27], s83 offen offset:2048 lds
    buffer_load_dwordx4 v7, s[24:27], s83 offen offset:3072 lds
    s_add_u32 m0, s73, 4096
    s_add_u32 s83, s83, 0x40000
    buffer_load_dwordx4 v4, s[24:27], s83 offen offset:0 lds
    buffer_load_dwordx4 v5, s[24:27], s83 offen offset:1024 lds
    buffer_load_dwordx4 v6, s[24:27], s83 offen offset:2048 lds
    buffer_load_dwordx4 v7, s[24:27], s83 offen offset:3072 lds
    s_and_b32 s76, s76, s57
    s_add_u32 s83, s76, s81
    s_add_u32 m0, s73, 32768
    s_addk_i32 s83, 0x200
    s_addk_i32 s76, 128
    buffer_load_dwordx4 v4, s[24:27], s83 offen offset:0 lds
    buffer_load_dwordx4 v5, s[24:27], s83 offen offset:1024 lds
    buffer_load_dwordx4 v6, s[24:27], s83 offen offset:2048 lds
    buffer_load_dwordx4 v7, s[24:27], s83 offen offset:3072 lds
    s_add_u32 m0, s73, 36864
    s_add_u32 s83, s83, 0x40000
    buffer_load_dwordx4 v4, s[24:27], s83 offen offset:0 lds
    buffer_load_dwordx4 v5, s[24:27], s83 offen offset:1024 lds
    buffer_load_dwordx4 v6, s[24:27], s83 offen offset:2048 lds
    buffer_load_dwordx4 v7, s[24:27], s83 offen offset:3072 lds
    s_and_b32 s76, s76, s57
    s_mul_i32 s79, s77, 128
    s_add_u32 m0, s73, 16384
    s_add_u32 s79, s79, s70
    s_addk_i32 s77, 128
    buffer_load_dwordx4 v46, s[28:31], s79 offen offset:0 lds
    buffer_load_dwordx4 v46, s[28:31], s79 offen offset:1024 lds
    buffer_load_dwordx4 v46, s[28:31], s79 offen offset:2048 lds
    buffer_load_dwordx4 v46, s[28:31], s79 offen offset:3072 lds
    s_add_u32 m0, s73, 20480
    s_add_u32 s79, s79, 4096
    buffer_load_dwordx4 v46, s[28:31], s79 offen offset:0 lds
    buffer_load_dwordx4 v46, s[28:31], s79 offen offset:1024 lds
    buffer_load_dwordx4 v46, s[28:31], s79 offen offset:2048 lds
    buffer_load_dwordx4 v46, s[28:31], s79 offen offset:3072 lds
    s_and_b32 s77, s77, s72
    s_mul_i32 s79, s77, 128
    s_add_u32 m0, s73, 49152
    s_add_u32 s79, s79, s70
    s_addk_i32 s77, 128
    buffer_load_dwordx4 v46, s[28:31], s79 offen offset:0 lds
    buffer_load_dwordx4 v46, s[28:31], s79 offen offset:1024 lds
    buffer_load_dwordx4 v46, s[28:31], s79 offen offset:2048 lds
    buffer_load_dwordx4 v46, s[28:31], s79 offen offset:3072 lds
    s_add_u32 m0, s73, 53248
    s_add_u32 s79, s79, 4096
    buffer_load_dwordx4 v46, s[28:31], s79 offen offset:0 lds
    buffer_load_dwordx4 v46, s[28:31], s79 offen offset:1024 lds
    buffer_load_dwordx4 v46, s[28:31], s79 offen offset:2048 lds
    buffer_load_dwordx4 v46, s[28:31], s79 offen offset:3072 lds
    s_and_b32 s77, s77, s72
    s_waitcnt vmcnt(16)
    s_barrier
    s_add_u32 s83, s76, s81
    s_add_u32 m0, s73, 65536
    s_nop 0
    buffer_load_dwordx4 v4, s[24:27], s83 offen offset:0 lds
    buffer_load_dwordx4 v5, s[24:27], s83 offen offset:1024 lds
    buffer_load_dwordx4 v6, s[24:27], s83 offen offset:2048 lds
    buffer_load_dwordx4 v7, s[24:27], s83 offen offset:3072 lds
    s_add_u32 m0, s73, 69632
    s_add_u32 s83, s83, 0x40000
    buffer_load_dwordx4 v4, s[24:27], s83 offen offset:0 lds
    buffer_load_dwordx4 v5, s[24:27], s83 offen offset:1024 lds
    buffer_load_dwordx4 v6, s[24:27], s83 offen offset:2048 lds
    buffer_load_dwordx4 v7, s[24:27], s83 offen offset:3072 lds
    s_and_b32 s76, s76, s57
    s_mul_i32 s79, s77, 128
    s_add_u32 m0, s73, 81920
    s_add_u32 s79, s79, s70
    s_addk_i32 s77, 128
    buffer_load_dwordx4 v46, s[28:31], s79 offen offset:0 lds
    buffer_load_dwordx4 v46, s[28:31], s79 offen offset:1024 lds
    buffer_load_dwordx4 v46, s[28:31], s79 offen offset:2048 lds
    buffer_load_dwordx4 v46, s[28:31], s79 offen offset:3072 lds
    s_add_u32 m0, s73, 86016
    s_add_u32 s79, s79, 4096
    buffer_load_dwordx4 v46, s[28:31], s79 offen offset:0 lds
    buffer_load_dwordx4 v46, s[28:31], s79 offen offset:1024 lds
    buffer_load_dwordx4 v46, s[28:31], s79 offen offset:2048 lds
    buffer_load_dwordx4 v46, s[28:31], s79 offen offset:3072 lds
    s_and_b32 s77, s77, s72
    s_waitcnt vmcnt(16)
    s_barrier
    s_add_u32 s83, s76, s81
    s_add_u32 m0, s73, 98304
    s_addk_i32 s83, 0x200
    s_addk_i32 s76, 128
    buffer_load_dwordx4 v4, s[24:27], s83 offen offset:0 lds
    buffer_load_dwordx4 v5, s[24:27], s83 offen offset:1024 lds
    buffer_load_dwordx4 v6, s[24:27], s83 offen offset:2048 lds
    buffer_load_dwordx4 v7, s[24:27], s83 offen offset:3072 lds
    s_add_u32 m0, s73, 102400
    s_add_u32 s83, s83, 0x40000
    buffer_load_dwordx4 v4, s[24:27], s83 offen offset:0 lds
    buffer_load_dwordx4 v5, s[24:27], s83 offen offset:1024 lds
    buffer_load_dwordx4 v6, s[24:27], s83 offen offset:2048 lds
    buffer_load_dwordx4 v7, s[24:27], s83 offen offset:3072 lds
    s_and_b32 s76, s76, s57
    s_mul_i32 s79, s77, 128
    s_add_u32 m0, s73, 114688
    s_add_u32 s79, s79, s70
    s_addk_i32 s77, 128
    buffer_load_dwordx4 v46, s[28:31], s79 offen offset:0 lds
    buffer_load_dwordx4 v46, s[28:31], s79 offen offset:1024 lds
    buffer_load_dwordx4 v46, s[28:31], s79 offen offset:2048 lds
    buffer_load_dwordx4 v46, s[28:31], s79 offen offset:3072 lds
    s_add_u32 m0, s73, 118784
    s_add_u32 s79, s79, 4096
    buffer_load_dwordx4 v46, s[28:31], s79 offen offset:0 lds
    buffer_load_dwordx4 v46, s[28:31], s79 offen offset:1024 lds
    buffer_load_dwordx4 v46, s[28:31], s79 offen offset:2048 lds
    buffer_load_dwordx4 v46, s[28:31], s79 offen offset:3072 lds
    s_and_b32 s77, s77, s72
    s_waitcnt vmcnt(16)
    s_barrier
    s_add_u32 s83, s76, s81
    s_add_u32 m0, s73, 0
    s_nop 0
    buffer_load_dwordx4 v4, s[24:27], s83 offen offset:0 lds
    buffer_load_dwordx4 v5, s[24:27], s83 offen offset:1024 lds
    buffer_load_dwordx4 v6, s[24:27], s83 offen offset:2048 lds
    buffer_load_dwordx4 v7, s[24:27], s83 offen offset:3072 lds
    s_add_u32 m0, s73, 4096
    s_add_u32 s83, s83, 0x40000
    buffer_load_dwordx4 v4, s[24:27], s83 offen offset:0 lds
    buffer_load_dwordx4 v5, s[24:27], s83 offen offset:1024 lds
    buffer_load_dwordx4 v6, s[24:27], s83 offen offset:2048 lds
    buffer_load_dwordx4 v7, s[24:27], s83 offen offset:3072 lds
    s_and_b32 s76, s76, s57
    s_mul_i32 s79, s77, 128
    s_add_u32 m0, s73, 16384
    s_add_u32 s79, s79, s70
    s_addk_i32 s77, 128
    buffer_load_dwordx4 v46, s[28:31], s79 offen offset:0 lds
    buffer_load_dwordx4 v46, s[28:31], s79 offen offset:1024 lds
    buffer_load_dwordx4 v46, s[28:31], s79 offen offset:2048 lds
    buffer_load_dwordx4 v46, s[28:31], s79 offen offset:3072 lds
    s_add_u32 m0, s73, 20480
    s_add_u32 s79, s79, 4096
    buffer_load_dwordx4 v46, s[28:31], s79 offen offset:0 lds
    buffer_load_dwordx4 v46, s[28:31], s79 offen offset:1024 lds
    buffer_load_dwordx4 v46, s[28:31], s79 offen offset:2048 lds
    buffer_load_dwordx4 v46, s[28:31], s79 offen offset:3072 lds
    s_and_b32 s77, s77, s72
    s_waitcnt vmcnt(16)
    s_barrier
    s_add_u32 s83, s76, s81
    s_add_u32 m0, s73, 32768
    s_addk_i32 s83, 0x200
    s_addk_i32 s76, 128
    buffer_load_dwordx4 v4, s[24:27], s83 offen offset:0 lds
    buffer_load_dwordx4 v5, s[24:27], s83 offen offset:1024 lds
    buffer_load_dwordx4 v6, s[24:27], s83 offen offset:2048 lds
    buffer_load_dwordx4 v7, s[24:27], s83 offen offset:3072 lds
    s_add_u32 m0, s73, 36864
    s_add_u32 s83, s83, 0x40000
    buffer_load_dwordx4 v4, s[24:27], s83 offen offset:0 lds
    buffer_load_dwordx4 v5, s[24:27], s83 offen offset:1024 lds
    buffer_load_dwordx4 v6, s[24:27], s83 offen offset:2048 lds
    buffer_load_dwordx4 v7, s[24:27], s83 offen offset:3072 lds
    s_and_b32 s76, s76, s57
    s_mul_i32 s79, s77, 128
    s_add_u32 m0, s73, 49152
    s_add_u32 s79, s79, s70
    s_addk_i32 s77, 128
    buffer_load_dwordx4 v46, s[28:31], s79 offen offset:0 lds
    buffer_load_dwordx4 v46, s[28:31], s79 offen offset:1024 lds
    buffer_load_dwordx4 v46, s[28:31], s79 offen offset:2048 lds
    buffer_load_dwordx4 v46, s[28:31], s79 offen offset:3072 lds
    s_add_u32 m0, s73, 53248
    s_add_u32 s79, s79, 4096
    buffer_load_dwordx4 v46, s[28:31], s79 offen offset:0 lds
    buffer_load_dwordx4 v46, s[28:31], s79 offen offset:1024 lds
    buffer_load_dwordx4 v46, s[28:31], s79 offen offset:2048 lds
    buffer_load_dwordx4 v46, s[28:31], s79 offen offset:3072 lds
    s_and_b32 s77, s77, s72
    s_waitcnt vmcnt(16)
    s_barrier
    s_add_u32 s83, s76, s81
    s_add_u32 m0, s73, 65536
    s_nop 0
    buffer_load_dwordx4 v4, s[24:27], s83 offen offset:0 lds
    buffer_load_dwordx4 v5, s[24:27], s83 offen offset:1024 lds
    buffer_load_dwordx4 v6, s[24:27], s83 offen offset:2048 lds
    buffer_load_dwordx4 v7, s[24:27], s83 offen offset:3072 lds
    s_add_u32 m0, s73, 69632
    s_add_u32 s83, s83, 0x40000
    buffer_load_dwordx4 v4, s[24:27], s83 offen offset:0 lds
    buffer_load_dwordx4 v5, s[24:27], s83 offen offset:1024 lds
    buffer_load_dwordx4 v6, s[24:27], s83 offen offset:2048 lds
    buffer_load_dwordx4 v7, s[24:27], s83 offen offset:3072 lds
    s_and_b32 s76, s76, s57
    s_mul_i32 s79, s77, 128
    s_add_u32 m0, s73, 81920
    s_add_u32 s79, s79, s70
    s_addk_i32 s77, 128
    buffer_load_dwordx4 v46, s[28:31], s79 offen offset:0 lds
    buffer_load_dwordx4 v46, s[28:31], s79 offen offset:1024 lds
    buffer_load_dwordx4 v46, s[28:31], s79 offen offset:2048 lds
    buffer_load_dwordx4 v46, s[28:31], s79 offen offset:3072 lds
    s_add_u32 m0, s73, 86016
    s_add_u32 s79, s79, 4096
    buffer_load_dwordx4 v46, s[28:31], s79 offen offset:0 lds
    buffer_load_dwordx4 v46, s[28:31], s79 offen offset:1024 lds
    buffer_load_dwordx4 v46, s[28:31], s79 offen offset:2048 lds
    buffer_load_dwordx4 v46, s[28:31], s79 offen offset:3072 lds
    s_and_b32 s77, s77, s72
    s_waitcnt vmcnt(16)
    s_barrier
    s_add_u32 s83, s76, s81
    s_add_u32 m0, s73, 98304
    s_addk_i32 s83, 0x200
    s_addk_i32 s76, 128
    buffer_load_dwordx4 v4, s[24:27], s83 offen offset:0 lds
    buffer_load_dwordx4 v5, s[24:27], s83 offen offset:1024 lds
    buffer_load_dwordx4 v6, s[24:27], s83 offen offset:2048 lds
    buffer_load_dwordx4 v7, s[24:27], s83 offen offset:3072 lds
    s_add_u32 m0, s73, 102400
    s_add_u32 s83, s83, 0x40000
    buffer_load_dwordx4 v4, s[24:27], s83 offen offset:0 lds
    buffer_load_dwordx4 v5, s[24:27], s83 offen offset:1024 lds
    buffer_load_dwordx4 v6, s[24:27], s83 offen offset:2048 lds
    buffer_load_dwordx4 v7, s[24:27], s83 offen offset:3072 lds
    s_and_b32 s76, s76, s57
    s_mul_i32 s79, s77, 128
    s_add_u32 m0, s73, 114688
    s_add_u32 s79, s79, s70
    s_addk_i32 s77, 128
    buffer_load_dwordx4 v46, s[28:31], s79 offen offset:0 lds
    buffer_load_dwordx4 v46, s[28:31], s79 offen offset:1024 lds
    buffer_load_dwordx4 v46, s[28:31], s79 offen offset:2048 lds
    buffer_load_dwordx4 v46, s[28:31], s79 offen offset:3072 lds
    s_add_u32 m0, s73, 118784
    s_add_u32 s79, s79, 4096
    buffer_load_dwordx4 v46, s[28:31], s79 offen offset:0 lds
    buffer_load_dwordx4 v46, s[28:31], s79 offen offset:1024 lds
    buffer_load_dwordx4 v46, s[28:31], s79 offen offset:2048 lds
    buffer_load_dwordx4 v46, s[28:31], s79 offen offset:3072 lds
    s_and_b32 s77, s77, s72
    s_waitcnt vmcnt(16)
    s_barrier
    s_waitcnt vmcnt(0)
    s_barrier
    s_getpc_b64 s[22:23]
PC2_k1_kernel:
    s_and_b32 s63, s2, 0xf8
    v_min_u32 v26, 7, v1
    v_add_lshl_u32 v26, v26, s63, 7
    s_add_u32 s22, s22, k2_kernel-PC2_k1_kernel
    s_addc_u32 s23, s23, 0
    v_min_u32 v26, CODE_END-k2_kernel-4, v26
    global_load_dword v8, v26, s[22:23]
    s_getpc_b64 s[22:23]
    s_add_u32 s22, s22, CTAB@rel32@lo+4
    s_addc_u32 s23, s23, CTAB@rel32@hi+12
    s_lshr_b32 s63, s63, 1
    v_add_lshl_u32 v26, v21, s63, 7
    global_load_dword v9, v26, s[22:23]
    s_endpgm
K1_STAT:
    s_and_b32 s54, s3, 1
    s_lshl_b32 s63, s54, 6
    v_add_u32 v25, s63, v1
    v_lshlrev_b32 v26, 3, v25
    v_add_u32 v26, 131072, v26
    v_lshlrev_b32 v27, 2, v25
    v_add_u32 v27, 132096, v27
    s_getpc_b64 s[22:23]
PC3_k1_kernel:
    s_and_b32 s63, s2, 0xf8
    v_min_u32 v8, 7, v1
    v_add_lshl_u32 v8, v8, s63, 6
    v_and_b32 v8, 0xffffff80, v8
    s_add_u32 s22, s22, k1_kernel-PC3_k1_kernel
    s_addc_u32 s23, s23, -1
    v_lshl_add_u32 v8, s54, 14, v8
    v_min_u32 v8, CODE_END-k1_kernel-4, v8
    global_load_dword v9, v8, s[22:23]
    v_mov_b32 v104, 0
    v_mov_b32 v105, 0
    ds_write_b64 v26, v[104:105] offset:17408
    s_getpc_b64 s[22:23]
    s_add_u32 s22, s22, FB2@rel32@lo+4
    s_addc_u32 s23, s23, FB2@rel32@hi+12
    s_lshr_b32 s63, s2, 3
    s_lshl1_add_u32 s63, s63, s54
    s_lshl_b32 s63, s63, 11
    s_lshl_b32 s64, s56, 17
    s_add_u32 s63, s63, s64
    v_lshl_add_u32 v8, v3, 7, s63
    global_load_dword v10, v8, s[22:23]
    v_mov_b32 v36, 0
    s_waitcnt lgkmcnt(0)
    s_cmp_eq_u32 s60, 0
    s_cbranch_scc1 FJ4_k1_kernel
    s_barrier
    s_barrier
    s_barrier
    s_barrier
    s_barrier
    s_barrier
    s_barrier
    s_barrier
    s_barrier
    s_branch FE5_k1_kernel
FJ4_k1_kernel:
    v_mov_b32 v44, v26
    v_mov_b32 v45, v27
    v_and_b32 v22, 7, v0
    s_add_u32 s75, s2, 56
    s_add_u32 s54, s54, 2
    s_barrier
    s_barrier
    s_barrier
    s_and_b32 s62, s54, 1
    s_lshl1_add_u32 s63, s75, s62
    s_and_b32 s69, s63, 7
    s_lshr_b32 s63, s63, 3
    s_lshl_b32 s63, s63, 1
    s_and_b32 s64, s63, 3
    s_and_b32 s65, s63, 12
    s_lshl4_add_u32 s64, s65, s64
    s_and_b32 s65, s63, 32
    s_lshl3_add_u32 s64, s65, s64
    s_lshr_b32 s65, s63, 6
    s_lshl3_add_u32 s64, s65, s64
    s_and_b32 s65, s63, 16
    s_lshl2_add_u32 s64, s64, s65
    s_mulk_i32 s64, 257
    s_lshl4_add_u32 s64, s69, s64
    s_lshl4_add_u32 s64, s69, s64
    s_lshl_b32 s64, s64, 1
    s_add_u32 s64, s64, 2
    s_lshl_b32 s69, s69, 12
    s_add_u32 s69, s69, s63
    s_lshl_b32 s69, s69, 6
    s_add_u32 s84, s69, 10485760
    s_mov_b32 s46, 1052672
    s_mov_b32 s47, 0x20000
    s_mov_b32 s50, 1052672
    s_mov_b32 s51, 0x20000
    s_mul_i32 s53, s54, 0x1800
    s_add_u32 s53, s53, 133120
    s_cmp_ge_u32 s54, 2
    s_cselect_b32 s63, 6144, 0
    s_add_u32 s53, s53, s63
    v_bfe_u32 v24, v0, 2, 2
    v_lshl_add_u32 v32, v24, 6, v2
    v_mul_u32_u24 v32, 514, v32
    v_lshl_add_u32 v32, v21, 4, v32
    v_lshrrev_b32 v12, 2, v1
    v_add_u32 v39, s53, v46
    v_lshlrev_b32 v37, 6, v12
    v_lshl_add_u32 v37, v21, 3, v37
    v_add_u32 v37, s53, v37
    v_lshlrev_b32 v27, 4, v2
    v_lshl_add_u32 v27, v3, 7, v27
    v_add_u32 v27, s53, v27
    v_lshrrev_b32 v36, 3, v1
    v_lshlrev_b32 v36, 13, v36
    v_lshl_add_u32 v36, v22, 4, v36
    s_barrier
    s_barrier
    buffer_load_dwordx4 v[52:55], v32, s[44:47], s64 offen offset:0
    buffer_load_dwordx4 v[56:59], v32, s[48:51], s64 offen offset:0
    buffer_load_dwordx4 v[68:71], v32, s[44:47], s64 offen offset:2056
    buffer_load_dwordx4 v[72:75], v32, s[48:51], s64 offen offset:2056
    v_mov_b32 v47, v27
    v_mov_b32 v26, v44
    v_mov_b32 v27, v45
    s_barrier
    s_barrier
    s_barrier
    s_barrier
FE5_k1_kernel:
    ds_read_b64 v[104:105], v26 offset:16384
    ds_read_b64 v[106:107], v26 offset:17408
    s_waitcnt lgkmcnt(0)
    v_add_f32 v104, v104, v106
    v_add_f32 v105, v105, v107
    s_mov_b32 s92, 0x3b000000
    s_mov_b32 s93, 0xffff0000
    s_mov_b32 s91, 0x3727c5ac
    v_mul_f32 v104, s92, v104
    v_mul_f32 v105, s92, v105
    v_fma_f32 v105, -v104, v104, v105
    v_max_f32 v105, 0, v105
    v_cvt_pk_bf16_f32 v105, v105, -v104
    v_and_b32 v106, s93, v105
    v_lshlrev_b32 v105, 16, v105
    v_add_f32 v105, s91, v105
    v_cvt_pk_bf16_f32 v105, v105, v105
    v_lshlrev_b32 v105, 16, v105
    v_sqrt_f32 v105, v105
    s_nop 0
    v_cvt_pk_bf16_f32 v105, v105, v105
    v_lshlrev_b32 v105, 16, v105
    v_rcp_f32 v108, v105
    s_nop 0
    v_mul_f32 v107, 0xbfb8aa3b, v108
    ds_write_b32 v27, v108
    ds_write_b64 v26, v[106:107]
    s_waitcnt lgkmcnt(0)
    s_barrier
    s_cmp_lg_u32 s60, 0
    s_cbranch_scc1 END_k1_kernel
    v_mov_b32 v27, v47
    s_waitcnt vmcnt(0)
    ds_write_b128 v39, v[52:55] offset:0
    ds_write_b128 v39, v[56:59] offset:1024
    ds_read_b64_tr_b16 v[52:53], v37 offset:0
    ds_read_b64_tr_b16 v[54:55], v37 offset:1024
    ds_read_b64_tr_b16 v[56:57], v37 offset:32
    ds_read_b64_tr_b16 v[58:59], v37 offset:1056
    s_waitcnt lgkmcnt(2)
    ds_write_b128 v27, v[52:55] offset:2048
    s_waitcnt lgkmcnt(1)
    ds_write_b128 v27, v[56:59] offset:4096
    ds_write_b128 v39, v[68:71] offset:0
    ds_write_b128 v39, v[72:75] offset:1024
    ds_read_b64_tr_b16 v[68:69], v37 offset:0
    ds_read_b64_tr_b16 v[70:71], v37 offset:1024
    ds_read_b64_tr_b16 v[72:73], v37 offset:32
    ds_read_b64_tr_b16 v[74:75], v37 offset:1056
    s_waitcnt lgkmcnt(2)
    ds_write_b128 v27, v[68:71] offset:2112
    s_waitcnt lgkmcnt(1)
    ds_write_b128 v27, v[72:75] offset:4160
    ds_read_b128 v[84:87], v39 offset:2048
    ds_read_b128 v[88:91], v39 offset:3072
    ds_read_b128 v[92:95], v39 offset:4096
    ds_read_b128 v[96:99], v39 offset:5120
    s_waitcnt lgkmcnt(3)
    buffer_store_dwordx4 v[84:87], v36, s[36:39], s84 offen sc1
    s_add_u32 s84, s84, 0x10000
    s_waitcnt lgkmcnt(2)
    buffer_store_dwordx4 v[88:91], v36, s[36:39], s84 offen sc1
    s_add_u32 s84, s84, 0x10000
    s_waitcnt lgkmcnt(1)
    buffer_store_dwordx4 v[92:95], v36, s[36:39], s84 offen sc1
    s_add_u32 s84, s84, 0x10000
    s_waitcnt lgkmcnt(0)
    buffer_store_dwordx4 v[96:99], v36, s[36:39], s84 offen sc1
    s_endpgm
K1_MMA:
    s_cmp_eq_u32 s60, 7
    s_cbranch_scc1 K1_FM
    s_and_b32 s54, s3, 1
    s_lshr_b32 s55, s3, 1
    s_lshl_b32 s74, s54, 13
    v_lshrrev_b32 v23, 1, v3
    v_xor_b32 v23, v23, v2
    v_lshl_add_u32 v20, v3, 7, s74
    v_lshl_add_u32 v44, v23, 4, v20
    v_xor_b32 v45, 64, v44
    v_bfe_u32 v24, v0, 2, 2
    v_lshlrev_b32 v23, 11, v2
    v_lshl_add_u32 v23, v24, 7, v23
    v_lshl_add_u32 v23, v21, 3, v23
    s_mul_i32 s63, s55, 0x2400
    s_addk_i32 s63, 0x4000
    v_add_u32 v23, s63, v23
    s_lshl_b32 s63, s55, 6
    v_xor_b32 v44, s63, v44
    v_xor_b32 v45, s63, v45
    s_movk_i32 s79, 0x400
    v_bfe_u32 v26, v0, 3, 2
    s_lshl_b32 s62, s54, 1
    v_xor_b32 v26, s62, v26
    v_xor_b32 v27, 0, v26
    v_lshl_add_u32 v4, v27, 5, v23
    v_xor_b32 v8, s79, v4
    v_xor_b32 v27, 1, v26
    v_lshl_add_u32 v5, v27, 5, v23
    v_xor_b32 v9, s79, v5
    v_xor_b32 v27, 2, v26
    v_lshl_add_u32 v6, v27, 5, v23
    v_xor_b32 v10, s79, v6
    v_xor_b32 v27, 3, v26
    v_lshl_add_u32 v7, v27, 5, v23
    v_xor_b32 v11, s79, v7
    v_pk_mov_b32 v[116:117], 0, 0
    v_pk_mov_b32 v[118:119], 0, 0
    v_pk_mov_b32 v[120:121], 0, 0
    v_pk_mov_b32 v[122:123], 0, 0
    v_pk_mov_b32 v[124:125], 0, 0
    v_pk_mov_b32 v[126:127], 0, 0
    v_pk_mov_b32 v[128:129], 0, 0
    v_pk_mov_b32 v[130:131], 0, 0
    v_pk_mov_b32 v[132:133], 0, 0
    v_pk_mov_b32 v[134:135], 0, 0
    v_pk_mov_b32 v[136:137], 0, 0
    v_pk_mov_b32 v[138:139], 0, 0
    v_pk_mov_b32 v[140:141], 0, 0
    v_pk_mov_b32 v[142:143], 0, 0
    v_pk_mov_b32 v[144:145], 0, 0
    v_pk_mov_b32 v[146:147], 0, 0
    v_pk_mov_b32 v[148:149], 0, 0
    v_pk_mov_b32 v[150:151], 0, 0
    v_pk_mov_b32 v[152:153], 0, 0
    v_pk_mov_b32 v[154:155], 0, 0
    v_pk_mov_b32 v[156:157], 0, 0
    v_pk_mov_b32 v[158:159], 0, 0
    v_pk_mov_b32 v[160:161], 0, 0
    v_pk_mov_b32 v[162:163], 0, 0
    v_pk_mov_b32 v[164:165], 0, 0
    v_pk_mov_b32 v[166:167], 0, 0
    v_pk_mov_b32 v[168:169], 0, 0
    v_pk_mov_b32 v[170:171], 0, 0
    v_pk_mov_b32 v[172:173], 0, 0
    v_pk_mov_b32 v[174:175], 0, 0
    v_pk_mov_b32 v[176:177], 0, 0
    v_pk_mov_b32 v[178:179], 0, 0
    v_pk_mov_b32 v[180:181], 0, 0
    v_pk_mov_b32 v[182:183], 0, 0
    v_pk_mov_b32 v[184:185], 0, 0
    v_pk_mov_b32 v[186:187], 0, 0
    v_pk_mov_b32 v[188:189], 0, 0
    v_pk_mov_b32 v[190:191], 0, 0
    v_pk_mov_b32 v[192:193], 0, 0
    v_pk_mov_b32 v[194:195], 0, 0
    v_pk_mov_b32 v[196:197], 0, 0
    v_pk_mov_b32 v[198:199], 0, 0
    v_pk_mov_b32 v[200:201], 0, 0
    v_pk_mov_b32 v[202:203], 0, 0
    v_pk_mov_b32 v[204:205], 0, 0
    v_pk_mov_b32 v[206:207], 0, 0
    v_pk_mov_b32 v[208:209], 0, 0
    v_pk_mov_b32 v[210:211], 0, 0
    v_pk_mov_b32 v[212:213], 0, 0
    v_pk_mov_b32 v[214:215], 0, 0
    v_pk_mov_b32 v[216:217], 0, 0
    v_pk_mov_b32 v[218:219], 0, 0
    s_waitcnt lgkmcnt(0)
    s_barrier
    ds_read_b128 v[52:55], v44 offset:0
    ds_read_b64_tr_b16 v[84:85], v4 offset:0
    ds_read_b64_tr_b16 v[86:87], v4 offset:512
    ds_read_b128 v[56:59], v44 offset:2048
    ds_read_b128 v[60:63], v44 offset:4096
    ds_read_b128 v[64:67], v44 offset:6144
    ds_read_b64_tr_b16 v[88:89], v5 offset:0
    ds_read_b64_tr_b16 v[90:91], v5 offset:512
    ds_read_b64_tr_b16 v[92:93], v6 offset:0
    ds_read_b64_tr_b16 v[94:95], v6 offset:512
    ds_read_b64_tr_b16 v[96:97], v7 offset:0
    ds_read_b64_tr_b16 v[98:99], v7 offset:512
    s_lshl_b32 s61, s55, 8
    s_add_u32 s61, s61, 132608
    v_lshl_add_u32 v28, v2, 4, s61
    s_xor_b32 s78, s62, 0
    s_mul_i32 s77, s78, 0x1200
    s_and_b32 s84, s77, 0x2200
    s_add_u32 s88, s84, 458752
    v_lshl_add_u32 v48, s78, 6, v28
    s_xor_b32 s78, s62, 1
    s_mul_i32 s77, s78, 0x1200
    s_and_b32 s85, s77, 0x2200
    s_add_u32 s89, s85, 458752
    s_xor_b32 s78, s62, 2
    s_mul_i32 s77, s78, 0x1200
    s_and_b32 s86, s77, 0x2200
    s_add_u32 s90, s86, 458752
    v_lshl_add_u32 v49, s78, 6, v28
    s_xor_b32 s78, s62, 3
    s_mul_i32 s77, s78, 0x1200
    s_and_b32 s87, s77, 0x2200
    s_add_u32 s91, s87, 458752
    s_lshl1_add_u32 s63, s55, s54
    s_lshl_b32 s63, s63, 9
    v_cmp_eq_u32 s[94:95], 1, v21
    v_cmp_eq_u32 s[96:97], 2, v21
    v_cmp_eq_u32 s[98:99], 3, v21
    s_mov_b32 vcc_lo, 0x00f0000f
    s_mov_b32 vcc_hi, 0xf0000f00
    s_add_u32 s63, s63, 147456
    v_lshl_add_u32 v13, v3, 3, s63
    v_lshlrev_b32 v27, 3, v1
    v_add_u32 v27, 149504, v27
    v_cndmask_b32 v13, v27, v13, vcc
    v_mov_b32 v220, 0x3f803f80
    v_mov_b32 v221, v220
    v_mov_b32 v222, v220
    v_mov_b32 v223, v220
    v_and_b32 v18, 16, v0
    v_lshlrev_b32 v18, 8, v18
    v_and_b32 v26, 32, v0
    v_lshl_or_b32 v18, v26, 3, v18
    v_lshl_or_b32 v18, v3, 4, v18
    s_mul_i32 s70, s56, 7
    s_add_u32 s60, s60, s70
    s_and_b32 s63, s58, 12
    s_add_u32 s63, s63, s62
    s_mul_i32 s63, s63, 28
    s_lshl1_add_u32 s63, s60, s63
    s_add_u32 s63, s63, s55
    s_and_b32 s62, s58, 3
    s_lshl4_add_u32 s63, s63, s62
    s_lshl_b32 s63, s63, 10
    v_add_u32 v18, s63, v18
    s_lshl_b32 s63, s54, 9
    s_add_u32 s63, s63, 131072
    v_lshl_add_u32 v17, v3, 3, s63
    s_mov_b32 s77, 0x10000
    s_mov_b32 s78, 0
K1H_LOOP:
    s_waitcnt lgkmcnt(9)
    v_mfma_f32_16x16x32_bf16 v[116:119], v[84:87], v[52:55], v[116:119]
    ds_read_b128 v[68:71], v45 offset:0
    s_waitcnt lgkmcnt(9)
    v_mfma_f32_16x16x32_bf16 v[120:123], v[84:87], v[56:59], v[120:123]
    ds_read_b64_tr_b16 v[100:101], v8 offset:0
    s_waitcnt lgkmcnt(9)
    v_mfma_f32_16x16x32_bf16 v[124:127], v[84:87], v[60:63], v[124:127]
    ds_read_b64_tr_b16 v[102:103], v8 offset:512
    s_waitcnt lgkmcnt(9)
    v_mfma_f32_16x16x32_bf16 v[128:131], v[84:87], v[64:67], v[128:131]
    ds_read_b128 v[72:75], v45 offset:2048
    v_mfma_f32_16x16x32_bf16 v[188:191], v[220:223], v[52:55], v[188:191]
    ds_read_b128 v[76:79], v45 offset:4096
    v_mfma_f32_16x16x32_bf16 v[204:207], v[52:55], v[52:55], v[204:207]
    ds_read_b128 v[80:83], v45 offset:6144
    v_mfma_f32_16x16x32_bf16 v[192:195], v[220:223], v[56:59], v[192:195]
    ds_read_b64_tr_b16 v[104:105], v9 offset:0
    v_mfma_f32_16x16x32_bf16 v[208:211], v[56:59], v[56:59], v[208:211]
    ds_read_b64_tr_b16 v[106:107], v9 offset:512
    v_mfma_f32_16x16x32_bf16 v[196:199], v[220:223], v[60:63], v[196:199]
    ds_read_b64_tr_b16 v[108:109], v10 offset:0
    v_mfma_f32_16x16x32_bf16 v[212:215], v[60:63], v[60:63], v[212:215]
    s_waitcnt lgkmcnt(14)
    ds_read_b64_tr_b16 v[110:111], v10 offset:512
    v_mfma_f32_16x16x32_bf16 v[200:203], v[220:223], v[64:67], v[200:203]
    s_waitcnt lgkmcnt(14)
    ds_read_b64_tr_b16 v[112:113], v11 offset:0
    v_mfma_f32_16x16x32_bf16 v[216:219], v[64:67], v[64:67], v[216:219]
    s_waitcnt lgkmcnt(14)
    ds_read_b64_tr_b16 v[114:115], v11 offset:512
    v_mfma_f32_16x16x32_bf16 v[132:135], v[88:91], v[52:55], v[132:135]
    v_mfma_f32_16x16x32_bf16 v[136:139], v[88:91], v[56:59], v[136:139]
    v_mfma_f32_16x16x32_bf16 v[140:143], v[88:91], v[60:63], v[140:143]
    v_mfma_f32_16x16x32_bf16 v[144:147], v[88:91], v[64:67], v[144:147]
    s_waitcnt lgkmcnt(14)
    v_mfma_f32_16x16x32_bf16 v[148:151], v[92:95], v[52:55], v[148:151]
    v_mfma_f32_16x16x32_bf16 v[152:155], v[92:95], v[56:59], v[152:155]
    v_mfma_f32_16x16x32_bf16 v[156:159], v[92:95], v[60:63], v[156:159]
    v_mfma_f32_16x16x32_bf16 v[160:163], v[92:95], v[64:67], v[160:163]
    s_waitcnt lgkmcnt(12)
    v_mfma_f32_16x16x32_bf16 v[164:167], v[96:99], v[52:55], v[164:167]
    v_mfma_f32_16x16x32_bf16 v[168:171], v[96:99], v[56:59], v[168:171]
    v_mfma_f32_16x16x32_bf16 v[172:175], v[96:99], v[60:63], v[172:175]
    v_mfma_f32_16x16x32_bf16 v[176:179], v[96:99], v[64:67], v[176:179]
    v_mfma_f32_16x16x32_bf16 v[180:183], v[84:87], v[220:223], v[180:183]
    v_mfma_f32_16x16x32_bf16 v[184:187], v[88:91], v[220:223], v[184:187]
    s_waitcnt lgkmcnt(0)
    s_barrier
    v_mfma_f32_16x16x32_bf16 v[116:119], v[100:103], v[68:71], v[116:119]
    ds_read_b128 v[52:55], v44 offset:32768
    v_mfma_f32_16x16x32_bf16 v[120:123], v[100:103], v[72:75], v[120:123]
    ds_read_b64_tr_b16 v[84:85], v4 offset:32768
    v_mfma_f32_16x16x32_bf16 v[124:127], v[100:103], v[76:79], v[124:127]
    ds_read_b64_tr_b16 v[86:87], v4 offset:33280
    v_mfma_f32_16x16x32_bf16 v[128:131], v[100:103], v[80:83], v[128:131]
    ds_read_b128 v[56:59], v44 offset:34816
    v_mfma_f32_16x16x32_bf16 v[132:135], v[104:107], v[68:71], v[132:135]
    ds_read_b128 v[60:63], v44 offset:36864
    v_mfma_f32_16x16x32_bf16 v[136:139], v[104:107], v[72:75], v[136:139]
    ds_read_b128 v[64:67], v44 offset:38912
    v_mfma_f32_16x16x32_bf16 v[140:143], v[104:107], v[76:79], v[140:143]
    ds_read_b64_tr_b16 v[88:89], v5 offset:32768
    v_mfma_f32_16x16x32_bf16 v[144:147], v[104:107], v[80:83], v[144:147]
    ds_read_b64_tr_b16 v[90:91], v5 offset:33280
    v_mfma_f32_16x16x32_bf16 v[148:151], v[108:111], v[68:71], v[148:151]
    ds_read_b64_tr_b16 v[92:93], v6 offset:32768
    v_mfma_f32_16x16x32_bf16 v[152:155], v[108:111], v[72:75], v[152:155]
    ds_read_b64_tr_b16 v[94:95], v6 offset:33280
    v_mfma_f32_16x16x32_bf16 v[156:159], v[108:111], v[76:79], v[156:159]
    ds_read_b64_tr_b16 v[96:97], v7 offset:32768
    v_mfma_f32_16x16x32_bf16 v[160:163], v[108:111], v[80:83], v[160:163]
    ds_read_b64_tr_b16 v[98:99], v7 offset:33280
    v_mfma_f32_16x16x32_bf16 v[164:167], v[112:115], v[68:71], v[164:167]
    v_mfma_f32_16x16x32_bf16 v[168:171], v[112:115], v[72:75], v[168:171]
    v_mfma_f32_16x16x32_bf16 v[172:175], v[112:115], v[76:79], v[172:175]
    v_mfma_f32_16x16x32_bf16 v[176:179], v[112:115], v[80:83], v[176:179]
    v_mfma_f32_16x16x32_bf16 v[180:183], v[100:103], v[220:223], v[180:183]
    v_mfma_f32_16x16x32_bf16 v[184:187], v[104:107], v[220:223], v[184:187]
    s_waitcnt lgkmcnt(9)
    v_mfma_f32_16x16x32_bf16 v[116:119], v[84:87], v[52:55], v[116:119]
    ds_read_b128 v[68:71], v45 offset:32768
    v_xor_b32 v44, s77, v44
    s_waitcnt lgkmcnt(9)
    v_mfma_f32_16x16x32_bf16 v[120:123], v[84:87], v[56:59], v[120:123]
    ds_read_b64_tr_b16 v[100:101], v8 offset:32768
    v_xor_b32 v4, s77, v4
    s_waitcnt lgkmcnt(9)
    v_mfma_f32_16x16x32_bf16 v[124:127], v[84:87], v[60:63], v[124:127]
    ds_read_b64_tr_b16 v[102:103], v8 offset:33280
    v_xor_b32 v5, s77, v5
    s_waitcnt lgkmcnt(9)
    v_mfma_f32_16x16x32_bf16 v[128:131], v[84:87], v[64:67], v[128:131]
    ds_read_b128 v[72:75], v45 offset:34816
    v_xor_b32 v6, s77, v6
    v_mfma_f32_16x16x32_bf16 v[188:191], v[220:223], v[52:55], v[188:191]
    ds_read_b128 v[76:79], v45 offset:36864
    v_xor_b32 v7, s77, v7
    v_mfma_f32_16x16x32_bf16 v[204:207], v[52:55], v[52:55], v[204:207]
    ds_read_b128 v[80:83], v45 offset:38912
    v_mfma_f32_16x16x32_bf16 v[192:195], v[220:223], v[56:59], v[192:195]
    ds_read_b64_tr_b16 v[104:105], v9 offset:32768
    v_mfma_f32_16x16x32_bf16 v[208:211], v[56:59], v[56:59], v[208:211]
    ds_read_b64_tr_b16 v[106:107], v9 offset:33280
    v_mfma_f32_16x16x32_bf16 v[196:199], v[220:223], v[60:63], v[196:199]
    ds_read_b64_tr_b16 v[108:109], v10 offset:32768
    v_mfma_f32_16x16x32_bf16 v[212:215], v[60:63], v[60:63], v[212:215]
    s_waitcnt lgkmcnt(14)
    ds_read_b64_tr_b16 v[110:111], v10 offset:33280
    v_mfma_f32_16x16x32_bf16 v[200:203], v[220:223], v[64:67], v[200:203]
    s_waitcnt lgkmcnt(14)
    ds_read_b64_tr_b16 v[112:113], v11 offset:32768
    v_mfma_f32_16x16x32_bf16 v[216:219], v[64:67], v[64:67], v[216:219]
    s_waitcnt lgkmcnt(14)
    ds_read_b64_tr_b16 v[114:115], v11 offset:33280
    v_mfma_f32_16x16x32_bf16 v[132:135], v[88:91], v[52:55], v[132:135]
    v_xor_b32 v45, s77, v45
    v_mfma_f32_16x16x32_bf16 v[136:139], v[88:91], v[56:59], v[136:139]
    v_xor_b32 v8, s77, v8
    v_mfma_f32_16x16x32_bf16 v[140:143], v[88:91], v[60:63], v[140:143]
    v_xor_b32 v9, s77, v9
    v_mfma_f32_16x16x32_bf16 v[144:147], v[88:91], v[64:67], v[144:147]
    v_xor_b32 v10, s77, v10
    s_waitcnt lgkmcnt(14)
    v_mfma_f32_16x16x32_bf16 v[148:151], v[92:95], v[52:55], v[148:151]
    v_xor_b32 v11, s77, v11
    v_mfma_f32_16x16x32_bf16 v[152:155], v[92:95], v[56:59], v[152:155]
    v_cndmask_b32 v233, v204, v205, s[94:95]
    v_mov_b32 v232, v188
    v_mfma_f32_16x16x32_bf16 v[156:159], v[92:95], v[60:63], v[156:159]
    v_cndmask_b32 v235, v208, v209, s[94:95]
    v_mov_b32 v234, v192
    v_mfma_f32_16x16x32_bf16 v[160:163], v[92:95], v[64:67], v[160:163]
    v_cndmask_b32 v237, v212, v213, s[94:95]
    v_mov_b32 v236, v196
    s_waitcnt lgkmcnt(12)
    v_mfma_f32_16x16x32_bf16 v[164:167], v[96:99], v[52:55], v[164:167]
    v_cndmask_b32 v239, v216, v217, s[94:95]
    v_mov_b32 v238, v200
    v_mfma_f32_16x16x32_bf16 v[168:171], v[96:99], v[56:59], v[168:171]
    v_cndmask_b32 v233, v233, v206, s[96:97]
    v_cndmask_b32 v235, v235, v210, s[96:97]
    v_mfma_f32_16x16x32_bf16 v[172:175], v[96:99], v[60:63], v[172:175]
    v_cndmask_b32 v237, v237, v214, s[96:97]
    v_cndmask_b32 v239, v239, v218, s[96:97]
    v_mfma_f32_16x16x32_bf16 v[176:179], v[96:99], v[64:67], v[176:179]
    v_cndmask_b32 v233, v233, v207, s[98:99]
    v_cndmask_b32 v235, v235, v211, s[98:99]
    v_mfma_f32_16x16x32_bf16 v[180:183], v[84:87], v[220:223], v[180:183]
    v_cndmask_b32 v237, v237, v215, s[98:99]
    v_cndmask_b32 v239, v239, v219, s[98:99]
    v_mfma_f32_16x16x32_bf16 v[184:187], v[88:91], v[220:223], v[184:187]
    ds_write_b64 v13, v[232:233] offset:0
    ds_write_b64 v13, v[234:235] offset:128
    ds_write_b64 v13, v[236:237] offset:256
    s_waitcnt lgkmcnt(14)
    ds_write_b64 v13, v[238:239] offset:384
    s_waitcnt lgkmcnt(0)
    s_barrier
    v_mfma_f32_16x16x32_bf16 v[116:119], v[100:103], v[68:71], v[116:119]
    ds_read_b128 v[52:55], v44 offset:0
    v_mfma_f32_16x16x32_bf16 v[120:123], v[100:103], v[72:75], v[120:123]
    ds_read_b64_tr_b16 v[84:85], v4 offset:0
    v_mfma_f32_16x16x32_bf16 v[124:127], v[100:103], v[76:79], v[124:127]
    ds_read_b64_tr_b16 v[86:87], v4 offset:512
    v_mfma_f32_16x16x32_bf16 v[128:131], v[100:103], v[80:83], v[128:131]
    ds_read_b128 v[56:59], v44 offset:2048
    v_mfma_f32_16x16x32_bf16 v[132:135], v[104:107], v[68:71], v[132:135]
    ds_read_b128 v[60:63], v44 offset:4096
    v_mfma_f32_16x16x32_bf16 v[136:139], v[104:107], v[72:75], v[136:139]
    ds_read_b128 v[64:67], v44 offset:6144
    v_mfma_f32_16x16x32_bf16 v[140:143], v[104:107], v[76:79], v[140:143]
    ds_read_b64_tr_b16 v[88:89], v5 offset:0
    v_mfma_f32_16x16x32_bf16 v[144:147], v[104:107], v[80:83], v[144:147]
    ds_read_b64_tr_b16 v[90:91], v5 offset:512
    v_mfma_f32_16x16x32_bf16 v[148:151], v[108:111], v[68:71], v[148:151]
    ds_read_b64_tr_b16 v[92:93], v6 offset:0
    v_mfma_f32_16x16x32_bf16 v[152:155], v[108:111], v[72:75], v[152:155]
    ds_read_b64_tr_b16 v[94:95], v6 offset:512
    v_mfma_f32_16x16x32_bf16 v[156:159], v[108:111], v[76:79], v[156:159]
    ds_read_b64_tr_b16 v[96:97], v7 offset:0
    v_mfma_f32_16x16x32_bf16 v[160:163], v[108:111], v[80:83], v[160:163]
    ds_read_b64_tr_b16 v[98:99], v7 offset:512
    v_mfma_f32_16x16x32_bf16 v[164:167], v[112:115], v[68:71], v[164:167]
    s_add_u32 s78, s78, 1
    s_cmp_lt_u32 s78, 4
    v_mfma_f32_16x16x32_bf16 v[168:171], v[112:115], v[72:75], v[168:171]
    v_mfma_f32_16x16x32_bf16 v[172:175], v[112:115], v[76:79], v[172:175]
    v_mfma_f32_16x16x32_bf16 v[176:179], v[112:115], v[80:83], v[176:179]
    v_mfma_f32_16x16x32_bf16 v[180:183], v[100:103], v[220:223], v[180:183]
    v_mfma_f32_16x16x32_bf16 v[184:187], v[104:107], v[220:223], v[184:187]
    s_cbranch_scc1 K1H_LOOP
    s_mov_b32 exec_lo, 0x10001
    s_mov_b32 exec_hi, 0x10001
    s_nop 3
    ds_write_b128 v48, v[180:183]
    ds_write_b128 v48, v[184:187] offset:64
    s_mov_b64 exec, -1
    s_waitcnt lgkmcnt(0)
    s_barrier
    ds_read_b64 v[224:225], v17 offset:0
    ds_read_b64 v[226:227], v17 offset:128
    ds_read_b64 v[228:229], v17 offset:256
    ds_read_b64 v[230:231], v17 offset:384
    ds_read_b128 v[52:55], v49 offset:0
    ds_read_b128 v[56:59], v49 offset:64
    s_waitcnt lgkmcnt(5)
    v_pk_fma_f32 v[116:117], v[224:225], v[180:181], v[116:117] op_sel_hi:[0,1,1]
    v_pk_fma_f32 v[118:119], v[224:225], v[182:183], v[118:119] op_sel_hi:[0,1,1]
    s_waitcnt lgkmcnt(4)
    v_pk_fma_f32 v[120:121], v[226:227], v[180:181], v[120:121] op_sel_hi:[0,1,1]
    v_pk_fma_f32 v[122:123], v[226:227], v[182:183], v[122:123] op_sel_hi:[0,1,1]
    v_pk_mul_f32 v[116:117], v[116:117], v[224:225] op_sel:[0,1] op_sel_hi:[1,1]
    v_pk_mul_f32 v[118:119], v[118:119], v[224:225] op_sel:[0,1] op_sel_hi:[1,1]
    v_pk_mul_f32 v[120:121], v[120:121], v[226:227] op_sel:[0,1] op_sel_hi:[1,1]
    v_pk_mul_f32 v[122:123], v[122:123], v[226:227] op_sel:[0,1] op_sel_hi:[1,1]
    v_exp_f32 v84, v116
    v_exp_f32 v85, v117
    v_exp_f32 v86, v118
    v_exp_f32 v87, v119
    v_exp_f32 v88, v120
    v_exp_f32 v89, v121
    v_exp_f32 v90, v122
    v_exp_f32 v91, v123
    v_pk_add_f32 v[84:85], v[84:85], 1.0 op_sel_hi:[1,0]
    v_pk_add_f32 v[86:87], v[86:87], 1.0 op_sel_hi:[1,0]
    v_pk_add_f32 v[88:89], v[88:89], 1.0 op_sel_hi:[1,0]
    v_pk_add_f32 v[90:91], v[90:91], 1.0 op_sel_hi:[1,0]
    v_rcp_f32 v84, v84
    v_rcp_f32 v85, v85
    v_rcp_f32 v86, v86
    v_rcp_f32 v87, v87
    v_rcp_f32 v88, v88
    v_rcp_f32 v89, v89
    v_rcp_f32 v90, v90
    v_rcp_f32 v91, v91
    v_pk_mul_f32 v[116:117], v[116:117], v[84:85]
    v_pk_mul_f32 v[118:119], v[118:119], v[86:87]
    v_pk_mul_f32 v[120:121], v[120:121], v[88:89]
    v_pk_mul_f32 v[122:123], v[122:123], v[90:91]
    v_cvt_pk_bf16_f32 v92, v116, v117
    v_cvt_pk_bf16_f32 v93, v118, v119
    v_cvt_pk_bf16_f32 v94, v120, v121
    v_cvt_pk_bf16_f32 v95, v122, v123
    s_nop 0
    v_permlane16_swap_b32 v92, v94
    v_permlane16_swap_b32 v93, v95
    buffer_store_dwordx4 v[92:95], v18, s[36:39], s84 offen sc1
    s_waitcnt lgkmcnt(3)
    v_pk_fma_f32 v[124:125], v[228:229], v[180:181], v[124:125] op_sel_hi:[0,1,1]
    v_pk_fma_f32 v[126:127], v[228:229], v[182:183], v[126:127] op_sel_hi:[0,1,1]
    s_waitcnt lgkmcnt(2)
    v_pk_fma_f32 v[128:129], v[230:231], v[180:181], v[128:129] op_sel_hi:[0,1,1]
    v_pk_fma_f32 v[130:131], v[230:231], v[182:183], v[130:131] op_sel_hi:[0,1,1]
    v_pk_mul_f32 v[124:125], v[124:125], v[228:229] op_sel:[0,1] op_sel_hi:[1,1]
    v_pk_mul_f32 v[126:127], v[126:127], v[228:229] op_sel:[0,1] op_sel_hi:[1,1]
    v_pk_mul_f32 v[128:129], v[128:129], v[230:231] op_sel:[0,1] op_sel_hi:[1,1]
    v_pk_mul_f32 v[130:131], v[130:131], v[230:231] op_sel:[0,1] op_sel_hi:[1,1]
    v_exp_f32 v96, v124
    v_exp_f32 v97, v125
    v_exp_f32 v98, v126
    v_exp_f32 v99, v127
    v_exp_f32 v100, v128
    v_exp_f32 v101, v129
    v_exp_f32 v102, v130
    v_exp_f32 v103, v131
    v_pk_add_f32 v[96:97], v[96:97], 1.0 op_sel_hi:[1,0]
    v_pk_add_f32 v[98:99], v[98:99], 1.0 op_sel_hi:[1,0]
    v_pk_add_f32 v[100:101], v[100:101], 1.0 op_sel_hi:[1,0]
    v_pk_add_f32 v[102:103], v[102:103], 1.0 op_sel_hi:[1,0]
    v_rcp_f32 v96, v96
    v_rcp_f32 v97, v97
    v_rcp_f32 v98, v98
    v_rcp_f32 v99, v99
    v_rcp_f32 v100, v100
    v_rcp_f32 v101, v101
    v_rcp_f32 v102, v102
    v_rcp_f32 v103, v103
    v_pk_mul_f32 v[124:125], v[124:125], v[96:97]
    v_pk_mul_f32 v[126:127], v[126:127], v[98:99]
    v_pk_mul_f32 v[128:129], v[128:129], v[100:101]
    v_pk_mul_f32 v[130:131], v[130:131], v[102:103]
    v_cvt_pk_bf16_f32 v104, v124, v125
    v_cvt_pk_bf16_f32 v105, v126, v127
    v_cvt_pk_bf16_f32 v106, v128, v129
    v_cvt_pk_bf16_f32 v107, v130, v131
    s_nop 0
    v_permlane16_swap_b32 v104, v106
    v_permlane16_swap_b32 v105, v107
    buffer_store_dwordx4 v[104:107], v18, s[36:39], s88 offen sc1
    v_pk_fma_f32 v[132:133], v[224:225], v[184:185], v[132:133] op_sel_hi:[0,1,1]
    v_pk_fma_f32 v[134:135], v[224:225], v[186:187], v[134:135] op_sel_hi:[0,1,1]
    v_pk_fma_f32 v[136:137], v[226:227], v[184:185], v[136:137] op_sel_hi:[0,1,1]
    v_pk_fma_f32 v[138:139], v[226:227], v[186:187], v[138:139] op_sel_hi:[0,1,1]
    v_pk_mul_f32 v[132:133], v[132:133], v[224:225] op_sel:[0,1] op_sel_hi:[1,1]
    v_pk_mul_f32 v[134:135], v[134:135], v[224:225] op_sel:[0,1] op_sel_hi:[1,1]
    v_pk_mul_f32 v[136:137], v[136:137], v[226:227] op_sel:[0,1] op_sel_hi:[1,1]
    v_pk_mul_f32 v[138:139], v[138:139], v[226:227] op_sel:[0,1] op_sel_hi:[1,1]
    v_exp_f32 v84, v132
    v_exp_f32 v85, v133
    v_exp_f32 v86, v134
    v_exp_f32 v87, v135
    v_exp_f32 v88, v136
    v_exp_f32 v89, v137
    v_exp_f32 v90, v138
    v_exp_f32 v91, v139
    v_pk_add_f32 v[84:85], v[84:85], 1.0 op_sel_hi:[1,0]
    v_pk_add_f32 v[86:87], v[86:87], 1.0 op_sel_hi:[1,0]
    v_pk_add_f32 v[88:89], v[88:89], 1.0 op_sel_hi:[1,0]
    v_pk_add_f32 v[90:91], v[90:91], 1.0 op_sel_hi:[1,0]
    v_rcp_f32 v84, v84
    v_rcp_f32 v85, v85
    v_rcp_f32 v86, v86
    v_rcp_f32 v87, v87
    v_rcp_f32 v88, v88
    v_rcp_f32 v89, v89
    v_rcp_f32 v90, v90
    v_rcp_f32 v91, v91
    v_pk_mul_f32 v[132:133], v[132:133], v[84:85]
    v_pk_mul_f32 v[134:135], v[134:135], v[86:87]
    v_pk_mul_f32 v[136:137], v[136:137], v[88:89]
    v_pk_mul_f32 v[138:139], v[138:139], v[90:91]
    v_cvt_pk_bf16_f32 v92, v132, v133
    v_cvt_pk_bf16_f32 v93, v134, v135
    v_cvt_pk_bf16_f32 v94, v136, v137
    v_cvt_pk_bf16_f32 v95, v138, v139
    s_nop 0
    v_permlane16_swap_b32 v92, v94
    v_permlane16_swap_b32 v93, v95
    buffer_store_dwordx4 v[92:95], v18, s[36:39], s85 offen sc1
    v_pk_fma_f32 v[140:141], v[228:229], v[184:185], v[140:141] op_sel_hi:[0,1,1]
    v_pk_fma_f32 v[142:143], v[228:229], v[186:187], v[142:143] op_sel_hi:[0,1,1]
    v_pk_fma_f32 v[144:145], v[230:231], v[184:185], v[144:145] op_sel_hi:[0,1,1]
    v_pk_fma_f32 v[146:147], v[230:231], v[186:187], v[146:147] op_sel_hi:[0,1,1]
    v_pk_mul_f32 v[140:141], v[140:141], v[228:229] op_sel:[0,1] op_sel_hi:[1,1]
    v_pk_mul_f32 v[142:143], v[142:143], v[228:229] op_sel:[0,1] op_sel_hi:[1,1]
    v_pk_mul_f32 v[144:145], v[144:145], v[230:231] op_sel:[0,1] op_sel_hi:[1,1]
    v_pk_mul_f32 v[146:147], v[146:147], v[230:231] op_sel:[0,1] op_sel_hi:[1,1]
    v_exp_f32 v96, v140
    v_exp_f32 v97, v141
    v_exp_f32 v98, v142
    v_exp_f32 v99, v143
    v_exp_f32 v100, v144
    v_exp_f32 v101, v145
    v_exp_f32 v102, v146
    v_exp_f32 v103, v147
    v_pk_add_f32 v[96:97], v[96:97], 1.0 op_sel_hi:[1,0]
    v_pk_add_f32 v[98:99], v[98:99], 1.0 op_sel_hi:[1,0]
    v_pk_add_f32 v[100:101], v[100:101], 1.0 op_sel_hi:[1,0]
    v_pk_add_f32 v[102:103], v[102:103], 1.0 op_sel_hi:[1,0]
    v_rcp_f32 v96, v96
    v_rcp_f32 v97, v97
    v_rcp_f32 v98, v98
    v_rcp_f32 v99, v99
    v_rcp_f32 v100, v100
    v_rcp_f32 v101, v101
    v_rcp_f32 v102, v102
    v_rcp_f32 v103, v103
    v_pk_mul_f32 v[140:141], v[140:141], v[96:97]
    v_pk_mul_f32 v[142:143], v[142:143], v[98:99]
    v_pk_mul_f32 v[144:145], v[144:145], v[100:101]
    v_pk_mul_f32 v[146:147], v[146:147], v[102:103]
    v_cvt_pk_bf16_f32 v104, v140, v141
    v_cvt_pk_bf16_f32 v105, v142, v143
    v_cvt_pk_bf16_f32 v106, v144, v145
    v_cvt_pk_bf16_f32 v107, v146, v147
    s_nop 0
    v_permlane16_swap_b32 v104, v106
    v_permlane16_swap_b32 v105, v107
    buffer_store_dwordx4 v[104:107], v18, s[36:39], s89 offen sc1
    s_waitcnt lgkmcnt(1)
    v_pk_fma_f32 v[148:149], v[224:225], v[52:53], v[148:149] op_sel_hi:[0,1,1]
    v_pk_fma_f32 v[150:151], v[224:225], v[54:55], v[150:151] op_sel_hi:[0,1,1]
    v_pk_fma_f32 v[152:153], v[226:227], v[52:53], v[152:153] op_sel_hi:[0,1,1]
    v_pk_fma_f32 v[154:155], v[226:227], v[54:55], v[154:155] op_sel_hi:[0,1,1]
    v_pk_mul_f32 v[148:149], v[148:149], v[224:225] op_sel:[0,1] op_sel_hi:[1,1]
    v_pk_mul_f32 v[150:151], v[150:151], v[224:225] op_sel:[0,1] op_sel_hi:[1,1]
    v_pk_mul_f32 v[152:153], v[152:153], v[226:227] op_sel:[0,1] op_sel_hi:[1,1]
    v_pk_mul_f32 v[154:155], v[154:155], v[226:227] op_sel:[0,1] op_sel_hi:[1,1]
    v_exp_f32 v84, v148
    v_exp_f32 v85, v149
    v_exp_f32 v86, v150
    v_exp_f32 v87, v151
    v_exp_f32 v88, v152
    v_exp_f32 v89, v153
    v_exp_f32 v90, v154
    v_exp_f32 v91, v155
    v_pk_add_f32 v[84:85], v[84:85], 1.0 op_sel_hi:[1,0]
    v_pk_add_f32 v[86:87], v[86:87], 1.0 op_sel_hi:[1,0]
    v_pk_add_f32 v[88:89], v[88:89], 1.0 op_sel_hi:[1,0]
    v_pk_add_f32 v[90:91], v[90:91], 1.0 op_sel_hi:[1,0]
    v_rcp_f32 v84, v84
    v_rcp_f32 v85, v85
    v_rcp_f32 v86, v86
    v_rcp_f32 v87, v87
    v_rcp_f32 v88, v88
    v_rcp_f32 v89, v89
    v_rcp_f32 v90, v90
    v_rcp_f32 v91, v91
    v_pk_mul_f32 v[148:149], v[148:149], v[84:85]
    v_pk_mul_f32 v[150:151], v[150:151], v[86:87]
    v_pk_mul_f32 v[152:153], v[152:153], v[88:89]
    v_pk_mul_f32 v[154:155], v[154:155], v[90:91]
    v_cvt_pk_bf16_f32 v92, v148, v149
    v_cvt_pk_bf16_f32 v93, v150, v151
    v_cvt_pk_bf16_f32 v94, v152, v153
    v_cvt_pk_bf16_f32 v95, v154, v155
    s_nop 0
    v_permlane16_swap_b32 v92, v94
    v_permlane16_swap_b32 v93, v95
    buffer_store_dwordx4 v[92:95], v18, s[36:39], s86 offen sc1
    v_pk_fma_f32 v[156:157], v[228:229], v[52:53], v[156:157] op_sel_hi:[0,1,1]
    v_pk_fma_f32 v[158:159], v[228:229], v[54:55], v[158:159] op_sel_hi:[0,1,1]
    v_pk_fma_f32 v[160:161], v[230:231], v[52:53], v[160:161] op_sel_hi:[0,1,1]
    v_pk_fma_f32 v[162:163], v[230:231], v[54:55], v[162:163] op_sel_hi:[0,1,1]
    v_pk_mul_f32 v[156:157], v[156:157], v[228:229] op_sel:[0,1] op_sel_hi:[1,1]
    v_pk_mul_f32 v[158:159], v[158:159], v[228:229] op_sel:[0,1] op_sel_hi:[1,1]
    v_pk_mul_f32 v[160:161], v[160:161], v[230:231] op_sel:[0,1] op_sel_hi:[1,1]
    v_pk_mul_f32 v[162:163], v[162:163], v[230:231] op_sel:[0,1] op_sel_hi:[1,1]
    v_exp_f32 v96, v156
    v_exp_f32 v97, v157
    v_exp_f32 v98, v158
    v_exp_f32 v99, v159
    v_exp_f32 v100, v160
    v_exp_f32 v101, v161
    v_exp_f32 v102, v162
    v_exp_f32 v103, v163
    v_pk_add_f32 v[96:97], v[96:97], 1.0 op_sel_hi:[1,0]
    v_pk_add_f32 v[98:99], v[98:99], 1.0 op_sel_hi:[1,0]
    v_pk_add_f32 v[100:101], v[100:101], 1.0 op_sel_hi:[1,0]
    v_pk_add_f32 v[102:103], v[102:103], 1.0 op_sel_hi:[1,0]
    v_rcp_f32 v96, v96
    v_rcp_f32 v97, v97
    v_rcp_f32 v98, v98
    v_rcp_f32 v99, v99
    v_rcp_f32 v100, v100
    v_rcp_f32 v101, v101
    v_rcp_f32 v102, v102
    v_rcp_f32 v103, v103
    v_pk_mul_f32 v[156:157], v[156:157], v[96:97]
    v_pk_mul_f32 v[158:159], v[158:159], v[98:99]
    v_pk_mul_f32 v[160:161], v[160:161], v[100:101]
    v_pk_mul_f32 v[162:163], v[162:163], v[102:103]
    v_cvt_pk_bf16_f32 v104, v156, v157
    v_cvt_pk_bf16_f32 v105, v158, v159
    v_cvt_pk_bf16_f32 v106, v160, v161
    v_cvt_pk_bf16_f32 v107, v162, v163
    s_nop 0
    v_permlane16_swap_b32 v104, v106
    v_permlane16_swap_b32 v105, v107
    buffer_store_dwordx4 v[104:107], v18, s[36:39], s90 offen sc1
    s_waitcnt lgkmcnt(0)
    v_pk_fma_f32 v[164:165], v[224:225], v[56:57], v[164:165] op_sel_hi:[0,1,1]
    v_pk_fma_f32 v[166:167], v[224:225], v[58:59], v[166:167] op_sel_hi:[0,1,1]
    v_pk_fma_f32 v[168:169], v[226:227], v[56:57], v[168:169] op_sel_hi:[0,1,1]
    v_pk_fma_f32 v[170:171], v[226:227], v[58:59], v[170:171] op_sel_hi:[0,1,1]
    v_pk_mul_f32 v[164:165], v[164:165], v[224:225] op_sel:[0,1] op_sel_hi:[1,1]
    v_pk_mul_f32 v[166:167], v[166:167], v[224:225] op_sel:[0,1] op_sel_hi:[1,1]
    v_pk_mul_f32 v[168:169], v[168:169], v[226:227] op_sel:[0,1] op_sel_hi:[1,1]
    v_pk_mul_f32 v[170:171], v[170:171], v[226:227] op_sel:[0,1] op_sel_hi:[1,1]
    v_exp_f32 v84, v164
    v_exp_f32 v85, v165
    v_exp_f32 v86, v166
    v_exp_f32 v87, v167
    v_exp_f32 v88, v168
    v_exp_f32 v89, v169
    v_exp_f32 v90, v170
    v_exp_f32 v91, v171
    v_pk_add_f32 v[84:85], v[84:85], 1.0 op_sel_hi:[1,0]
    v_pk_add_f32 v[86:87], v[86:87], 1.0 op_sel_hi:[1,0]
    v_pk_add_f32 v[88:89], v[88:89], 1.0 op_sel_hi:[1,0]
    v_pk_add_f32 v[90:91], v[90:91], 1.0 op_sel_hi:[1,0]
    v_rcp_f32 v84, v84
    v_rcp_f32 v85, v85
    v_rcp_f32 v86, v86
    v_rcp_f32 v87, v87
    v_rcp_f32 v88, v88
    v_rcp_f32 v89, v89
    v_rcp_f32 v90, v90
    v_rcp_f32 v91, v91
    v_pk_mul_f32 v[164:165], v[164:165], v[84:85]
    v_pk_mul_f32 v[166:167], v[166:167], v[86:87]
    v_pk_mul_f32 v[168:169], v[168:169], v[88:89]
    v_pk_mul_f32 v[170:171], v[170:171], v[90:91]
    v_cvt_pk_bf16_f32 v92, v164, v165
    v_cvt_pk_bf16_f32 v93, v166, v167
    v_cvt_pk_bf16_f32 v94, v168, v169
    v_cvt_pk_bf16_f32 v95, v170, v171
    s_nop 0
    v_permlane16_swap_b32 v92, v94
    v_permlane16_swap_b32 v93, v95
    buffer_store_dwordx4 v[92:95], v18, s[36:39], s87 offen sc1
    v_pk_fma_f32 v[172:173], v[228:229], v[56:57], v[172:173] op_sel_hi:[0,1,1]
    v_pk_fma_f32 v[174:175], v[228:229], v[58:59], v[174:175] op_sel_hi:[0,1,1]
    v_pk_fma_f32 v[176:177], v[230:231], v[56:57], v[176:177] op_sel_hi:[0,1,1]
    v_pk_fma_f32 v[178:179], v[230:231], v[58:59], v[178:179] op_sel_hi:[0,1,1]
    v_pk_mul_f32 v[172:173], v[172:173], v[228:229] op_sel:[0,1] op_sel_hi:[1,1]
    v_pk_mul_f32 v[174:175], v[174:175], v[228:229] op_sel:[0,1] op_sel_hi:[1,1]
    v_pk_mul_f32 v[176:177], v[176:177], v[230:231] op_sel:[0,1] op_sel_hi:[1,1]
    v_pk_mul_f32 v[178:179], v[178:179], v[230:231] op_sel:[0,1] op_sel_hi:[1,1]
    v_exp_f32 v96, v172
    v_exp_f32 v97, v173
    v_exp_f32 v98, v174
    v_exp_f32 v99, v175
    v_exp_f32 v100, v176
    v_exp_f32 v101, v177
    v_exp_f32 v102, v178
    v_exp_f32 v103, v179
    v_pk_add_f32 v[96:97], v[96:97], 1.0 op_sel_hi:[1,0]
    v_pk_add_f32 v[98:99], v[98:99], 1.0 op_sel_hi:[1,0]
    v_pk_add_f32 v[100:101], v[100:101], 1.0 op_sel_hi:[1,0]
    v_pk_add_f32 v[102:103], v[102:103], 1.0 op_sel_hi:[1,0]
    v_rcp_f32 v96, v96
    v_rcp_f32 v97, v97
    v_rcp_f32 v98, v98
    v_rcp_f32 v99, v99
    v_rcp_f32 v100, v100
    v_rcp_f32 v101, v101
    v_rcp_f32 v102, v102
    v_rcp_f32 v103, v103
    v_pk_mul_f32 v[172:173], v[172:173], v[96:97]
    v_pk_mul_f32 v[174:175], v[174:175], v[98:99]
    v_pk_mul_f32 v[176:177], v[176:177], v[100:101]
    v_pk_mul_f32 v[178:179], v[178:179], v[102:103]
    v_cvt_pk_bf16_f32 v104, v172, v173
    v_cvt_pk_bf16_f32 v105, v174, v175
    v_cvt_pk_bf16_f32 v106, v176, v177
    v_cvt_pk_bf16_f32 v107, v178, v179
    s_nop 0
    v_permlane16_swap_b32 v104, v106
    v_permlane16_swap_b32 v105, v107
    buffer_store_dwordx4 v[104:107], v18, s[36:39], s91 offen sc1
    s_endpgm
K1_FM:
    s_lshl_b32 s74, s3, 12
    v_lshrrev_b32 v23, 1, v3
    v_xor_b32 v23, v23, v2
    v_lshl_add_u32 v8, v3, 7, s74
    v_lshl_add_u32 v8, v23, 4, v8
    v_xor_b32 v9, 64, v8
    v_add_u32 v12, 0x4000, v46
    v_lshrrev_b32 v26, 3, v1
    v_lshlrev_b32 v11, 14, v26
    v_sub_u32 v26, v21, v26
    v_and_b32 v26, 3, v26
    v_lshl_or_b32 v11, v26, 4, v11
    v_and_b32 v26, 4, v0
    v_lshl_or_b32 v11, v26, 4, v11
    s_and_b32 s63, s58, 12
    s_add_u32 s63, s63, s3
    s_and_b32 s84, s58, 3
    s_lshl2_add_u32 s63, s63, s84
    s_lshl_b32 s63, s63, 7
    s_xor_b32 s84, s56, 1
    s_lshl_b32 s84, s84, 13
    s_add_u32 s84, s84, s63
    s_add_u32 s84, s84, 8388608
    s_lshl_b32 s53, s3, 12
    v_lshrrev_b32 v26, 1, v3
    v_add_u32 v26, v26, v2
    v_and_b32 v26, 3, v26
    v_lshl_add_u32 v14, v3, 6, s53
    v_lshl_add_u32 v14, v26, 4, v14
    v_add_u32 v15, s53, v46
    s_mov_b32 s85, 0x20000
    s_lshl_b32 s63, s3, 7
    s_add_u32 s63, s63, 132096
    v_lshl_add_u32 v10, v2, 4, s63
    s_mov_b32 s88, 0xffff0000
    s_lshl_b32 s86, s56, 31
    s_or_b32 s86, s86, 1.0
    s_mov_b32 s77, 0x10000
    s_mov_b32 s78, 0
    s_lshl_b32 s63, s3, 8
    v_cmp_eq_u32 s[94:95], 1, v21
    v_cmp_eq_u32 s[96:97], 2, v21
    v_cmp_eq_u32 s[98:99], 3, v21
    s_mov_b32 vcc_lo, 0x00f0000f
    s_mov_b32 vcc_hi, 0xf0000f00
    s_add_u32 s63, s63, 147456
    v_lshl_add_u32 v13, v3, 3, s63
    v_lshlrev_b32 v27, 3, v1
    v_add_u32 v27, 149504, v27
    v_cndmask_b32 v13, v27, v13, vcc
    v_mov_b32 v0, 0x3f803f80
    v_mov_b32 v1, v0
    v_mov_b32 v2, v0
    v_mov_b32 v3, v0
    v_pk_mov_b32 v[112:113], 0, 0
    v_pk_mov_b32 v[114:115], 0, 0
    v_pk_mov_b32 v[116:117], 0, 0
    v_pk_mov_b32 v[118:119], 0, 0
    v_pk_mov_b32 v[120:121], 0, 0
    v_pk_mov_b32 v[122:123], 0, 0
    v_pk_mov_b32 v[124:125], 0, 0
    v_pk_mov_b32 v[126:127], 0, 0
    v_pk_mov_b32 v[128:129], 0, 0
    v_pk_mov_b32 v[130:131], 0, 0
    v_pk_mov_b32 v[132:133], 0, 0
    v_pk_mov_b32 v[134:135], 0, 0
    v_pk_mov_b32 v[136:137], 0, 0
    v_pk_mov_b32 v[138:139], 0, 0
    v_pk_mov_b32 v[140:141], 0, 0
    v_pk_mov_b32 v[142:143], 0, 0
    v_pk_mov_b32 v[144:145], 0, 0
    v_pk_mov_b32 v[146:147], 0, 0
    v_pk_mov_b32 v[148:149], 0, 0
    v_pk_mov_b32 v[150:151], 0, 0
    v_pk_mov_b32 v[152:153], 0, 0
    v_pk_mov_b32 v[154:155], 0, 0
    v_pk_mov_b32 v[156:157], 0, 0
    v_pk_mov_b32 v[158:159], 0, 0
    v_pk_mov_b32 v[160:161], 0, 0
    v_pk_mov_b32 v[162:163], 0, 0
    v_pk_mov_b32 v[164:165], 0, 0
    v_pk_mov_b32 v[166:167], 0, 0
    v_pk_mov_b32 v[168:169], 0, 0
    v_pk_mov_b32 v[170:171], 0, 0
    v_pk_mov_b32 v[172:173], 0, 0
    v_pk_mov_b32 v[174:175], 0, 0
    v_pk_mov_b32 v[176:177], 0, 0
    v_pk_mov_b32 v[178:179], 0, 0
    v_pk_mov_b32 v[180:181], 0, 0
    v_pk_mov_b32 v[182:183], 0, 0
    v_pk_mov_b32 v[184:185], 0, 0
    v_pk_mov_b32 v[186:187], 0, 0
    v_pk_mov_b32 v[188:189], 0, 0
    v_pk_mov_b32 v[190:191], 0, 0
    v_pk_mov_b32 v[192:193], 0, 0
    v_pk_mov_b32 v[194:195], 0, 0
    v_pk_mov_b32 v[196:197], 0, 0
    v_pk_mov_b32 v[198:199], 0, 0
    v_pk_mov_b32 v[200:201], 0, 0
    v_pk_mov_b32 v[202:203], 0, 0
    v_pk_mov_b32 v[204:205], 0, 0
    v_pk_mov_b32 v[206:207], 0, 0
    v_pk_mov_b32 v[208:209], 0, 0
    v_pk_mov_b32 v[210:211], 0, 0
    v_pk_mov_b32 v[212:213], 0, 0
    v_pk_mov_b32 v[214:215], 0, 0
    v_pk_mov_b32 v[216:217], 0, 0
    v_pk_mov_b32 v[218:219], 0, 0
    v_pk_mov_b32 v[220:221], 0, 0
    v_pk_mov_b32 v[222:223], 0, 0
    v_pk_mov_b32 v[224:225], 0, 0
    v_pk_mov_b32 v[226:227], 0, 0
    v_pk_mov_b32 v[228:229], 0, 0
    v_pk_mov_b32 v[230:231], 0, 0
    v_pk_mov_b32 v[232:233], 0, 0
    v_pk_mov_b32 v[234:235], 0, 0
    v_pk_mov_b32 v[236:237], 0, 0
    v_pk_mov_b32 v[238:239], 0, 0
    v_pk_mov_b32 v[240:241], 0, 0
    v_pk_mov_b32 v[242:243], 0, 0
    v_pk_mov_b32 v[244:245], 0, 0
    v_pk_mov_b32 v[246:247], 0, 0
    v_pk_mov_b32 v[248:249], 0, 0
    v_pk_mov_b32 v[250:251], 0, 0
    v_pk_mov_b32 v[252:253], 0, 0
    v_pk_mov_b32 v[254:255], 0, 0
    s_waitcnt lgkmcnt(0)
    s_barrier
    ds_read_b128 v[16:19], v8 offset:0
    ds_read_b128 v[20:23], v8 offset:32768
    ds_read_b128 v[24:27], v8 offset:2048
    ds_read_b128 v[28:31], v8 offset:34816
    s_waitcnt lgkmcnt(3)
    v_lshlrev_b32 v4, 16, v16
    v_and_b32 v5, s88, v16
    s_waitcnt lgkmcnt(2)
    v_lshlrev_b32 v6, 16, v20
    v_and_b32 v7, s88, v20
    v_fmac_f32 v4, s86, v6
    v_fmac_f32 v5, s86, v7
    v_cvt_pk_bf16_f32 v32, v4, v5
    v_lshlrev_b32 v4, 16, v17
    v_and_b32 v5, s88, v17
    v_lshlrev_b32 v6, 16, v21
    v_and_b32 v7, s88, v21
    v_fmac_f32 v4, s86, v6
    v_fmac_f32 v5, s86, v7
    v_cvt_pk_bf16_f32 v33, v4, v5
    v_lshlrev_b32 v4, 16, v18
    v_and_b32 v5, s88, v18
    v_lshlrev_b32 v6, 16, v22
    v_and_b32 v7, s88, v22
    v_fmac_f32 v4, s86, v6
    v_fmac_f32 v5, s86, v7
    v_cvt_pk_bf16_f32 v34, v4, v5
    v_lshlrev_b32 v4, 16, v19
    v_and_b32 v5, s88, v19
    v_lshlrev_b32 v6, 16, v23
    v_and_b32 v7, s88, v23
    v_fmac_f32 v4, s86, v6
    v_fmac_f32 v5, s86, v7
    v_cvt_pk_bf16_f32 v35, v4, v5
    s_waitcnt lgkmcnt(1)
    v_lshlrev_b32 v4, 16, v24
    v_and_b32 v5, s88, v24
    s_waitcnt lgkmcnt(0)
    v_lshlrev_b32 v6, 16, v28
    v_and_b32 v7, s88, v28
    v_fmac_f32 v4, s86, v6
    v_fmac_f32 v5, s86, v7
    v_cvt_pk_bf16_f32 v36, v4, v5
    v_lshlrev_b32 v4, 16, v25
    v_and_b32 v5, s88, v25
    v_lshlrev_b32 v6, 16, v29
    v_and_b32 v7, s88, v29
    v_fmac_f32 v4, s86, v6
    v_fmac_f32 v5, s86, v7
    v_cvt_pk_bf16_f32 v37, v4, v5
    v_lshlrev_b32 v4, 16, v26
    v_and_b32 v5, s88, v26
    v_lshlrev_b32 v6, 16, v30
    v_and_b32 v7, s88, v30
    v_fmac_f32 v4, s86, v6
    v_fmac_f32 v5, s86, v7
    v_cvt_pk_bf16_f32 v38, v4, v5
    v_lshlrev_b32 v4, 16, v27
    v_and_b32 v5, s88, v27
    v_lshlrev_b32 v6, 16, v31
    v_and_b32 v7, s88, v31
    v_fmac_f32 v4, s86, v6
    v_fmac_f32 v5, s86, v7
    v_cvt_pk_bf16_f32 v39, v4, v5
    v_mfma_f32_16x16x32_bf16 v[112:115], v[0:3], v[16:19], v[112:115]
    v_mfma_f32_16x16x32_bf16 v[120:123], v[16:19], v[16:19], v[120:123]
    v_mfma_f32_16x16x32_bf16 v[112:115], v[0:3], v[20:23], v[112:115]
    v_mfma_f32_16x16x32_bf16 v[120:123], v[20:23], v[20:23], v[120:123]
    v_mfma_f32_16x16x32_bf16 v[116:119], v[0:3], v[24:27], v[116:119]
    v_mfma_f32_16x16x32_bf16 v[124:127], v[24:27], v[24:27], v[124:127]
    v_mfma_f32_16x16x32_bf16 v[116:119], v[0:3], v[28:31], v[116:119]
    v_mfma_f32_16x16x32_bf16 v[124:127], v[28:31], v[28:31], v[124:127]
    s_barrier
    ds_read_b128 v[48:51], v12 offset:0
    ds_read_b128 v[52:55], v12 offset:1024
    ds_read_b128 v[56:59], v12 offset:2048
    ds_read_b128 v[60:63], v12 offset:3072
    ds_read_b128 v[64:67], v12 offset:4096
    ds_read_b128 v[68:71], v12 offset:5120
    ds_read_b128 v[72:75], v12 offset:6144
    ds_read_b128 v[76:79], v12 offset:7168
    ds_read_b128 v[80:83], v12 offset:8192
    ds_read_b128 v[84:87], v12 offset:9216
    ds_read_b128 v[88:91], v12 offset:10240
    ds_read_b128 v[92:95], v12 offset:11264
    ds_read_b128 v[96:99], v12 offset:12288
    ds_read_b128 v[100:103], v12 offset:13312
    ds_read_b128 v[104:107], v12 offset:14336
    s_waitcnt lgkmcnt(14)
    ds_read_b128 v[108:111], v12 offset:15360
    s_waitcnt lgkmcnt(0)
    s_nop 1
    s_branch K1F_ENTRY
K1F_LOOP:
    s_barrier
    v_mfma_f32_16x16x32_bf16 v[128:131], v[40:43], v[48:51], v[128:131]
    ds_read_b128 v[16:19], v8 offset:0
    ds_read_b128 v[20:23], v8 offset:32768
    v_mfma_f32_16x16x32_bf16 v[132:135], v[44:47], v[48:51], v[132:135]
    ds_read_b128 v[24:27], v8 offset:2048
    ds_read_b128 v[28:31], v8 offset:34816
    ds_read_b128 v[48:51], v12 offset:0
    v_mfma_f32_16x16x32_bf16 v[136:139], v[40:43], v[52:55], v[136:139]
    v_mfma_f32_16x16x32_bf16 v[140:143], v[44:47], v[52:55], v[140:143]
    ds_read_b128 v[52:55], v12 offset:1024
    v_mfma_f32_16x16x32_bf16 v[144:147], v[40:43], v[56:59], v[144:147]
    v_mfma_f32_16x16x32_bf16 v[148:151], v[44:47], v[56:59], v[148:151]
    ds_read_b128 v[56:59], v12 offset:2048
    v_mfma_f32_16x16x32_bf16 v[152:155], v[40:43], v[60:63], v[152:155]
    s_waitcnt lgkmcnt(6)
    v_lshlrev_b32 v4, 16, v16
    v_and_b32 v5, s88, v16
    v_mfma_f32_16x16x32_bf16 v[156:159], v[44:47], v[60:63], v[156:159]
    s_waitcnt lgkmcnt(5)
    v_lshlrev_b32 v6, 16, v20
    ds_read_b128 v[60:63], v12 offset:3072
    v_mfma_f32_16x16x32_bf16 v[112:115], v[0:3], v[16:19], v[112:115]
    v_and_b32 v7, s88, v20
    v_fmac_f32 v4, s86, v6
    v_mfma_f32_16x16x32_bf16 v[120:123], v[16:19], v[16:19], v[120:123]
    v_fmac_f32 v5, s86, v7
    v_cvt_pk_bf16_f32 v32, v4, v5
    v_mfma_f32_16x16x32_bf16 v[160:163], v[40:43], v[64:67], v[160:163]
    v_lshlrev_b32 v4, 16, v17
    v_and_b32 v5, s88, v17
    v_mfma_f32_16x16x32_bf16 v[164:167], v[44:47], v[64:67], v[164:167]
    v_lshlrev_b32 v6, 16, v21
    ds_read_b128 v[64:67], v12 offset:4096
    v_mfma_f32_16x16x32_bf16 v[112:115], v[0:3], v[20:23], v[112:115]
    v_and_b32 v7, s88, v21
    v_fmac_f32 v4, s86, v6
    v_mfma_f32_16x16x32_bf16 v[120:123], v[20:23], v[20:23], v[120:123]
    v_fmac_f32 v5, s86, v7
    v_cvt_pk_bf16_f32 v33, v4, v5
    v_mfma_f32_16x16x32_bf16 v[168:171], v[40:43], v[68:71], v[168:171]
    v_lshlrev_b32 v4, 16, v18
    v_and_b32 v5, s88, v18
    v_mfma_f32_16x16x32_bf16 v[172:175], v[44:47], v[68:71], v[172:175]
    v_lshlrev_b32 v6, 16, v22
    ds_read_b128 v[68:71], v12 offset:5120
    s_waitcnt lgkmcnt(7)
    v_mfma_f32_16x16x32_bf16 v[116:119], v[0:3], v[24:27], v[116:119]
    v_and_b32 v7, s88, v22
    v_fmac_f32 v4, s86, v6
    v_mfma_f32_16x16x32_bf16 v[124:127], v[24:27], v[24:27], v[124:127]
    v_fmac_f32 v5, s86, v7
    v_cvt_pk_bf16_f32 v34, v4, v5
    v_mfma_f32_16x16x32_bf16 v[176:179], v[40:43], v[72:75], v[176:179]
    v_lshlrev_b32 v4, 16, v19
    v_and_b32 v5, s88, v19
    v_mfma_f32_16x16x32_bf16 v[180:183], v[44:47], v[72:75], v[180:183]
    v_lshlrev_b32 v6, 16, v23
    ds_read_b128 v[72:75], v12 offset:6144
    s_waitcnt lgkmcnt(7)
    v_mfma_f32_16x16x32_bf16 v[116:119], v[0:3], v[28:31], v[116:119]
    v_and_b32 v7, s88, v23
    v_fmac_f32 v4, s86, v6
    v_mfma_f32_16x16x32_bf16 v[124:127], v[28:31], v[28:31], v[124:127]
    v_fmac_f32 v5, s86, v7
    v_cvt_pk_bf16_f32 v35, v4, v5
    v_mfma_f32_16x16x32_bf16 v[184:187], v[40:43], v[76:79], v[184:187]
    v_lshlrev_b32 v4, 16, v24
    v_and_b32 v5, s88, v24
    v_mfma_f32_16x16x32_bf16 v[188:191], v[44:47], v[76:79], v[188:191]
    v_lshlrev_b32 v6, 16, v28
    ds_read_b128 v[76:79], v12 offset:7168
    v_mfma_f32_16x16x32_bf16 v[192:195], v[40:43], v[80:83], v[192:195]
    v_and_b32 v7, s88, v28
    v_fmac_f32 v4, s86, v6
    v_mfma_f32_16x16x32_bf16 v[196:199], v[44:47], v[80:83], v[196:199]
    v_fmac_f32 v5, s86, v7
    ds_read_b128 v[80:83], v12 offset:8192
    v_mfma_f32_16x16x32_bf16 v[200:203], v[40:43], v[84:87], v[200:203]
    v_cvt_pk_bf16_f32 v36, v4, v5
    v_lshlrev_b32 v4, 16, v25
    v_mfma_f32_16x16x32_bf16 v[204:207], v[44:47], v[84:87], v[204:207]
    v_and_b32 v5, s88, v25
    ds_read_b128 v[84:87], v12 offset:9216
    v_mfma_f32_16x16x32_bf16 v[208:211], v[40:43], v[88:91], v[208:211]
    v_lshlrev_b32 v6, 16, v29
    v_and_b32 v7, s88, v29
    v_mfma_f32_16x16x32_bf16 v[212:215], v[44:47], v[88:91], v[212:215]
    v_fmac_f32 v4, s86, v6
    ds_read_b128 v[88:91], v12 offset:10240
    v_mfma_f32_16x16x32_bf16 v[216:219], v[40:43], v[92:95], v[216:219]
    v_fmac_f32 v5, s86, v7
    v_cvt_pk_bf16_f32 v37, v4, v5
    v_mfma_f32_16x16x32_bf16 v[220:223], v[44:47], v[92:95], v[220:223]
    v_lshlrev_b32 v4, 16, v26
    ds_read_b128 v[92:95], v12 offset:11264
    v_mfma_f32_16x16x32_bf16 v[224:227], v[40:43], v[96:99], v[224:227]
    v_and_b32 v5, s88, v26
    v_lshlrev_b32 v6, 16, v30
    v_mfma_f32_16x16x32_bf16 v[228:231], v[44:47], v[96:99], v[228:231]
    v_and_b32 v7, s88, v30
    ds_read_b128 v[96:99], v12 offset:12288
    v_mfma_f32_16x16x32_bf16 v[232:235], v[40:43], v[100:103], v[232:235]
    v_fmac_f32 v4, s86, v6
    v_fmac_f32 v5, s86, v7
    v_mfma_f32_16x16x32_bf16 v[236:239], v[44:47], v[100:103], v[236:239]
    v_cvt_pk_bf16_f32 v38, v4, v5
    ds_read_b128 v[100:103], v12 offset:13312
    v_mfma_f32_16x16x32_bf16 v[240:243], v[40:43], v[104:107], v[240:243]
    v_lshlrev_b32 v4, 16, v27
    v_and_b32 v5, s88, v27
    v_mfma_f32_16x16x32_bf16 v[244:247], v[44:47], v[104:107], v[244:247]
    v_lshlrev_b32 v6, 16, v31
    ds_read_b128 v[104:107], v12 offset:14336
    v_mfma_f32_16x16x32_bf16 v[248:251], v[40:43], v[108:111], v[248:251]
    v_and_b32 v7, s88, v31
    v_fmac_f32 v4, s86, v6
    v_mfma_f32_16x16x32_bf16 v[252:255], v[44:47], v[108:111], v[252:255]
    v_fmac_f32 v5, s86, v7
    s_waitcnt lgkmcnt(14)
    ds_read_b128 v[108:111], v12 offset:15360
    v_cvt_pk_bf16_f32 v39, v4, v5
K1F_ENTRY:
    v_mfma_f32_16x16x32_bf16 v[128:131], v[32:35], v[48:51], v[128:131]
    s_waitcnt lgkmcnt(14)
    ds_read_b128 v[16:19], v9 offset:0
    s_waitcnt lgkmcnt(14)
    ds_read_b128 v[20:23], v9 offset:32768
    v_mfma_f32_16x16x32_bf16 v[132:135], v[36:39], v[48:51], v[132:135]
    s_waitcnt lgkmcnt(14)
    ds_read_b128 v[24:27], v9 offset:2048
    s_waitcnt lgkmcnt(14)
    ds_read_b128 v[28:31], v9 offset:34816
    s_waitcnt lgkmcnt(14)
    ds_read_b128 v[48:51], v12 offset:32768
    v_mfma_f32_16x16x32_bf16 v[136:139], v[32:35], v[52:55], v[136:139]
    v_mfma_f32_16x16x32_bf16 v[140:143], v[36:39], v[52:55], v[140:143]
    s_waitcnt lgkmcnt(14)
    ds_read_b128 v[52:55], v12 offset:33792
    v_mfma_f32_16x16x32_bf16 v[144:147], v[32:35], v[56:59], v[144:147]
    v_mfma_f32_16x16x32_bf16 v[148:151], v[36:39], v[56:59], v[148:151]
    s_waitcnt lgkmcnt(14)
    ds_read_b128 v[56:59], v12 offset:34816
    v_mfma_f32_16x16x32_bf16 v[152:155], v[32:35], v[60:63], v[152:155]
    s_waitcnt lgkmcnt(6)
    v_lshlrev_b32 v4, 16, v16
    v_and_b32 v5, s88, v16
    v_mfma_f32_16x16x32_bf16 v[156:159], v[36:39], v[60:63], v[156:159]
    s_waitcnt lgkmcnt(5)
    v_lshlrev_b32 v6, 16, v20
    ds_read_b128 v[60:63], v12 offset:35840
    v_mfma_f32_16x16x32_bf16 v[112:115], v[0:3], v[16:19], v[112:115]
    v_and_b32 v7, s88, v20
    v_fmac_f32 v4, s86, v6
    v_mfma_f32_16x16x32_bf16 v[120:123], v[16:19], v[16:19], v[120:123]
    v_fmac_f32 v5, s86, v7
    v_cvt_pk_bf16_f32 v40, v4, v5
    v_mfma_f32_16x16x32_bf16 v[160:163], v[32:35], v[64:67], v[160:163]
    v_lshlrev_b32 v4, 16, v17
    v_and_b32 v5, s88, v17
    v_mfma_f32_16x16x32_bf16 v[164:167], v[36:39], v[64:67], v[164:167]
    v_lshlrev_b32 v6, 16, v21
    ds_read_b128 v[64:67], v12 offset:36864
    v_mfma_f32_16x16x32_bf16 v[112:115], v[0:3], v[20:23], v[112:115]
    v_and_b32 v7, s88, v21
    v_fmac_f32 v4, s86, v6
    v_mfma_f32_16x16x32_bf16 v[120:123], v[20:23], v[20:23], v[120:123]
    v_fmac_f32 v5, s86, v7
    v_cvt_pk_bf16_f32 v41, v4, v5
    v_mfma_f32_16x16x32_bf16 v[168:171], v[32:35], v[68:71], v[168:171]
    v_lshlrev_b32 v4, 16, v18
    v_and_b32 v5, s88, v18
    v_mfma_f32_16x16x32_bf16 v[172:175], v[36:39], v[68:71], v[172:175]
    v_lshlrev_b32 v6, 16, v22
    ds_read_b128 v[68:71], v12 offset:37888
    s_waitcnt lgkmcnt(7)
    v_mfma_f32_16x16x32_bf16 v[116:119], v[0:3], v[24:27], v[116:119]
    v_and_b32 v7, s88, v22
    v_fmac_f32 v4, s86, v6
    v_mfma_f32_16x16x32_bf16 v[124:127], v[24:27], v[24:27], v[124:127]
    v_fmac_f32 v5, s86, v7
    v_cvt_pk_bf16_f32 v42, v4, v5
    v_mfma_f32_16x16x32_bf16 v[176:179], v[32:35], v[72:75], v[176:179]
    v_lshlrev_b32 v4, 16, v19
    v_and_b32 v5, s88, v19
    v_mfma_f32_16x16x32_bf16 v[180:183], v[36:39], v[72:75], v[180:183]
    v_lshlrev_b32 v6, 16, v23
    ds_read_b128 v[72:75], v12 offset:38912
    s_waitcnt lgkmcnt(7)
    v_mfma_f32_16x16x32_bf16 v[116:119], v[0:3], v[28:31], v[116:119]
    v_and_b32 v7, s88, v23
    v_fmac_f32 v4, s86, v6
    v_mfma_f32_16x16x32_bf16 v[124:127], v[28:31], v[28:31], v[124:127]
    v_fmac_f32 v5, s86, v7
    v_cvt_pk_bf16_f32 v43, v4, v5
    v_mfma_f32_16x16x32_bf16 v[184:187], v[32:35], v[76:79], v[184:187]
    v_lshlrev_b32 v4, 16, v24
    v_and_b32 v5, s88, v24
    v_mfma_f32_16x16x32_bf16 v[188:191], v[36:39], v[76:79], v[188:191]
    v_lshlrev_b32 v6, 16, v28
    ds_read_b128 v[76:79], v12 offset:39936
    v_mfma_f32_16x16x32_bf16 v[192:195], v[32:35], v[80:83], v[192:195]
    v_and_b32 v7, s88, v28
    v_fmac_f32 v4, s86, v6
    v_mfma_f32_16x16x32_bf16 v[196:199], v[36:39], v[80:83], v[196:199]
    v_fmac_f32 v5, s86, v7
    ds_read_b128 v[80:83], v12 offset:40960
    v_cvt_pk_bf16_f32 v44, v4, v5
    v_cndmask_b32 v5, v120, v121, s[94:95]
    v_mov_b32 v4, v112
    v_cndmask_b32 v7, v124, v125, s[94:95]
    v_mov_b32 v6, v116
    v_cndmask_b32 v5, v5, v122, s[96:97]
    v_cndmask_b32 v7, v7, v126, s[96:97]
    v_cndmask_b32 v5, v5, v123, s[98:99]
    v_cndmask_b32 v7, v7, v127, s[98:99]
    ds_write_b64 v13, v[4:5] offset:0
    ds_write_b64 v13, v[6:7] offset:128
    v_mfma_f32_16x16x32_bf16 v[200:203], v[32:35], v[84:87], v[200:203]
    v_lshlrev_b32 v4, 16, v25
    v_and_b32 v5, s88, v25
    v_mfma_f32_16x16x32_bf16 v[204:207], v[36:39], v[84:87], v[204:207]
    v_lshlrev_b32 v6, 16, v29
    ds_read_b128 v[84:87], v12 offset:41984
    v_mfma_f32_16x16x32_bf16 v[208:211], v[32:35], v[88:91], v[208:211]
    v_and_b32 v7, s88, v29
    v_fmac_f32 v4, s86, v6
    v_mfma_f32_16x16x32_bf16 v[212:215], v[36:39], v[88:91], v[212:215]
    v_fmac_f32 v5, s86, v7
    ds_read_b128 v[88:91], v12 offset:43008
    s_waitcnt lgkmcnt(2)
    s_barrier
    v_mfma_f32_16x16x32_bf16 v[216:219], v[32:35], v[92:95], v[216:219]
    v_cvt_pk_bf16_f32 v45, v4, v5
    v_lshlrev_b32 v4, 16, v26
    v_mfma_f32_16x16x32_bf16 v[220:223], v[36:39], v[92:95], v[220:223]
    v_and_b32 v5, s88, v26
    ds_read_b128 v[92:95], v12 offset:44032
    v_mfma_f32_16x16x32_bf16 v[224:227], v[32:35], v[96:99], v[224:227]
    v_lshlrev_b32 v6, 16, v30
    v_and_b32 v7, s88, v30
    v_mfma_f32_16x16x32_bf16 v[228:231], v[36:39], v[96:99], v[228:231]
    v_fmac_f32 v4, s86, v6
    ds_read_b128 v[96:99], v12 offset:45056
    v_mfma_f32_16x16x32_bf16 v[232:235], v[32:35], v[100:103], v[232:235]
    v_fmac_f32 v5, s86, v7
    v_cvt_pk_bf16_f32 v46, v4, v5
    v_mfma_f32_16x16x32_bf16 v[236:239], v[36:39], v[100:103], v[236:239]
    v_lshlrev_b32 v4, 16, v27
    ds_read_b128 v[100:103], v12 offset:46080
    v_mfma_f32_16x16x32_bf16 v[240:243], v[32:35], v[104:107], v[240:243]
    v_and_b32 v5, s88, v27
    v_lshlrev_b32 v6, 16, v31
    v_mfma_f32_16x16x32_bf16 v[244:247], v[36:39], v[104:107], v[244:247]
    v_and_b32 v7, s88, v31
    ds_read_b128 v[104:107], v12 offset:47104
    v_mfma_f32_16x16x32_bf16 v[248:251], v[32:35], v[108:111], v[248:251]
    v_fmac_f32 v4, s86, v6
    v_fmac_f32 v5, s86, v7
    v_mfma_f32_16x16x32_bf16 v[252:255], v[36:39], v[108:111], v[252:255]
    v_cvt_pk_bf16_f32 v47, v4, v5
    ds_read_b128 v[108:111], v12 offset:48128
    v_xor_b32 v8, s77, v8
    v_xor_b32 v9, s77, v9
    v_xor_b32 v12, s77, v12
    s_add_u32 s78, s78, 1
    s_cmp_lt_u32 s78, 4
    s_waitcnt lgkmcnt(0)
    s_cbranch_scc1 K1F_LOOP
    s_barrier
    ds_read_b128 v[32:35], v10 offset:0
    ds_read_b128 v[36:39], v10 offset:64
    v_mfma_f32_16x16x32_bf16 v[128:131], v[40:43], v[48:51], v[128:131]
    v_mfma_f32_16x16x32_bf16 v[132:135], v[44:47], v[48:51], v[132:135]
    v_mfma_f32_16x16x32_bf16 v[136:139], v[40:43], v[52:55], v[136:139]
    v_mfma_f32_16x16x32_bf16 v[140:143], v[44:47], v[52:55], v[140:143]
    v_mfma_f32_16x16x32_bf16 v[144:147], v[40:43], v[56:59], v[144:147]
    v_mfma_f32_16x16x32_bf16 v[148:151], v[44:47], v[56:59], v[148:151]
    v_mfma_f32_16x16x32_bf16 v[152:155], v[40:43], v[60:63], v[152:155]
    s_waitcnt lgkmcnt(1)
    s_nop 0
    v_pk_mul_f32 v[128:129], v[128:129], v[32:33]
    v_pk_mul_f32 v[130:131], v[130:131], v[34:35]
    s_waitcnt lgkmcnt(0)
    v_pk_mul_f32 v[132:133], v[132:133], v[36:37]
    v_pk_mul_f32 v[134:135], v[134:135], v[38:39]
    v_mfma_f32_16x16x32_bf16 v[156:159], v[44:47], v[60:63], v[156:159]
    v_cvt_pk_bf16_f32 v16, v128, v129
    v_cvt_pk_bf16_f32 v17, v130, v131
    v_cvt_pk_bf16_f32 v18, v132, v133
    v_cvt_pk_bf16_f32 v19, v134, v135
    ds_write_b128 v14, v[16:19] offset:0
    ds_read_b128 v[112:115], v15 offset:0
    v_mfma_f32_16x16x32_bf16 v[160:163], v[40:43], v[64:67], v[160:163]
    v_pk_mul_f32 v[136:137], v[136:137], v[32:33]
    v_pk_mul_f32 v[138:139], v[138:139], v[34:35]
    v_pk_mul_f32 v[140:141], v[140:141], v[36:37]
    v_pk_mul_f32 v[142:143], v[142:143], v[38:39]
    v_mfma_f32_16x16x32_bf16 v[164:167], v[44:47], v[64:67], v[164:167]
    v_cvt_pk_bf16_f32 v20, v136, v137
    v_cvt_pk_bf16_f32 v21, v138, v139
    v_cvt_pk_bf16_f32 v22, v140, v141
    v_cvt_pk_bf16_f32 v23, v142, v143
    ds_write_b128 v14, v[20:23] offset:1024
    ds_read_b128 v[116:119], v15 offset:1024
    v_mfma_f32_16x16x32_bf16 v[168:171], v[40:43], v[68:71], v[168:171]
    v_pk_mul_f32 v[144:145], v[144:145], v[32:33]
    v_pk_mul_f32 v[146:147], v[146:147], v[34:35]
    v_pk_mul_f32 v[148:149], v[148:149], v[36:37]
    v_pk_mul_f32 v[150:151], v[150:151], v[38:39]
    v_mfma_f32_16x16x32_bf16 v[172:175], v[44:47], v[68:71], v[172:175]
    v_cvt_pk_bf16_f32 v24, v144, v145
    v_cvt_pk_bf16_f32 v25, v146, v147
    v_cvt_pk_bf16_f32 v26, v148, v149
    v_cvt_pk_bf16_f32 v27, v150, v151
    ds_write_b128 v14, v[24:27] offset:2048
    ds_read_b128 v[120:123], v15 offset:2048
    v_mfma_f32_16x16x32_bf16 v[176:179], v[40:43], v[72:75], v[176:179]
    v_pk_mul_f32 v[152:153], v[152:153], v[32:33]
    v_pk_mul_f32 v[154:155], v[154:155], v[34:35]
    v_pk_mul_f32 v[156:157], v[156:157], v[36:37]
    v_pk_mul_f32 v[158:159], v[158:159], v[38:39]
    v_mfma_f32_16x16x32_bf16 v[180:183], v[44:47], v[72:75], v[180:183]
    v_cvt_pk_bf16_f32 v28, v152, v153
    v_cvt_pk_bf16_f32 v29, v154, v155
    v_cvt_pk_bf16_f32 v30, v156, v157
    v_cvt_pk_bf16_f32 v31, v158, v159
    s_waitcnt lgkmcnt(4)
    buffer_store_dwordx4 v[112:115], v11, s[36:39], s84 offen sc1
    s_add_u32 s84, s84, s85
    ds_write_b128 v14, v[28:31] offset:3072
    ds_read_b128 v[124:127], v15 offset:3072
    v_mfma_f32_16x16x32_bf16 v[184:187], v[40:43], v[76:79], v[184:187]
    v_pk_mul_f32 v[160:161], v[160:161], v[32:33]
    v_pk_mul_f32 v[162:163], v[162:163], v[34:35]
    v_pk_mul_f32 v[164:165], v[164:165], v[36:37]
    v_pk_mul_f32 v[166:167], v[166:167], v[38:39]
    v_mfma_f32_16x16x32_bf16 v[188:191], v[44:47], v[76:79], v[188:191]
    v_cvt_pk_bf16_f32 v16, v160, v161
    v_cvt_pk_bf16_f32 v17, v162, v163
    v_cvt_pk_bf16_f32 v18, v164, v165
    v_cvt_pk_bf16_f32 v19, v166, v167
    s_waitcnt lgkmcnt(4)
    buffer_store_dwordx4 v[116:119], v11, s[36:39], s84 offen sc1
    s_add_u32 s84, s84, s85
    ds_write_b128 v14, v[16:19] offset:0
    ds_read_b128 v[112:115], v15 offset:0
    v_mfma_f32_16x16x32_bf16 v[192:195], v[40:43], v[80:83], v[192:195]
    v_pk_mul_f32 v[168:169], v[168:169], v[32:33]
    v_pk_mul_f32 v[170:171], v[170:171], v[34:35]
    v_pk_mul_f32 v[172:173], v[172:173], v[36:37]
    v_pk_mul_f32 v[174:175], v[174:175], v[38:39]
    v_mfma_f32_16x16x32_bf16 v[196:199], v[44:47], v[80:83], v[196:199]
    v_cvt_pk_bf16_f32 v20, v168, v169
    v_cvt_pk_bf16_f32 v21, v170, v171
    v_cvt_pk_bf16_f32 v22, v172, v173
    v_cvt_pk_bf16_f32 v23, v174, v175
    s_waitcnt lgkmcnt(4)
    buffer_store_dwordx4 v[120:123], v11, s[36:39], s84 offen sc1
    s_add_u32 s84, s84, s85
    ds_write_b128 v14, v[20:23] offset:1024
    ds_read_b128 v[116:119], v15 offset:1024
    v_mfma_f32_16x16x32_bf16 v[200:203], v[40:43], v[84:87], v[200:203]
    v_pk_mul_f32 v[176:177], v[176:177], v[32:33]
    v_pk_mul_f32 v[178:179], v[178:179], v[34:35]
    v_pk_mul_f32 v[180:181], v[180:181], v[36:37]
    v_pk_mul_f32 v[182:183], v[182:183], v[38:39]
    v_mfma_f32_16x16x32_bf16 v[204:207], v[44:47], v[84:87], v[204:207]
    v_cvt_pk_bf16_f32 v24, v176, v177
    v_cvt_pk_bf16_f32 v25, v178, v179
    v_cvt_pk_bf16_f32 v26, v180, v181
    v_cvt_pk_bf16_f32 v27, v182, v183
    s_waitcnt lgkmcnt(4)
    buffer_store_dwordx4 v[124:127], v11, s[36:39], s84 offen sc1
    s_add_u32 s84, s84, s85
    ds_write_b128 v14, v[24:27] offset:2048
    ds_read_b128 v[120:123], v15 offset:2048
    v_mfma_f32_16x16x32_bf16 v[208:211], v[40:43], v[88:91], v[208:211]
    v_pk_mul_f32 v[184:185], v[184:185], v[32:33]
    v_pk_mul_f32 v[186:187], v[186:187], v[34:35]
    v_pk_mul_f32 v[188:189], v[188:189], v[36:37]
    v_pk_mul_f32 v[190:191], v[190:191], v[38:39]
    v_mfma_f32_16x16x32_bf16 v[212:215], v[44:47], v[88:91], v[212:215]
    v_cvt_pk_bf16_f32 v28, v184, v185
    v_cvt_pk_bf16_f32 v29, v186, v187
    v_cvt_pk_bf16_f32 v30, v188, v189
    v_cvt_pk_bf16_f32 v31, v190, v191
    s_waitcnt lgkmcnt(4)
    buffer_store_dwordx4 v[112:115], v11, s[36:39], s84 offen sc1
    s_add_u32 s84, s84, s85
    ds_write_b128 v14, v[28:31] offset:3072
    ds_read_b128 v[124:127], v15 offset:3072
    v_mfma_f32_16x16x32_bf16 v[216:219], v[40:43], v[92:95], v[216:219]
    v_pk_mul_f32 v[192:193], v[192:193], v[32:33]
    v_pk_mul_f32 v[194:195], v[194:195], v[34:35]
    v_pk_mul_f32 v[196:197], v[196:197], v[36:37]
    v_pk_mul_f32 v[198:199], v[198:199], v[38:39]
    v_mfma_f32_16x16x32_bf16 v[220:223], v[44:47], v[92:95], v[220:223]
    v_cvt_pk_bf16_f32 v16, v192, v193
    v_cvt_pk_bf16_f32 v17, v194, v195
    v_cvt_pk_bf16_f32 v18, v196, v197
    v_cvt_pk_bf16_f32 v19, v198, v199
    s_waitcnt lgkmcnt(4)
    buffer_store_dwordx4 v[116:119], v11, s[36:39], s84 offen sc1
    s_add_u32 s84, s84, s85
    ds_write_b128 v14, v[16:19] offset:0
    ds_read_b128 v[112:115], v15 offset:0
    v_mfma_f32_16x16x32_bf16 v[224:227], v[40:43], v[96:99], v[224:227]
    v_pk_mul_f32 v[200:201], v[200:201], v[32:33]
    v_pk_mul_f32 v[202:203], v[202:203], v[34:35]
    v_pk_mul_f32 v[204:205], v[204:205], v[36:37]
    v_pk_mul_f32 v[206:207], v[206:207], v[38:39]
    v_mfma_f32_16x16x32_bf16 v[228:231], v[44:47], v[96:99], v[228:231]
    v_cvt_pk_bf16_f32 v20, v200, v201
    v_cvt_pk_bf16_f32 v21, v202, v203
    v_cvt_pk_bf16_f32 v22, v204, v205
    v_cvt_pk_bf16_f32 v23, v206, v207
    s_waitcnt lgkmcnt(4)
    buffer_store_dwordx4 v[120:123], v11, s[36:39], s84 offen sc1
    s_add_u32 s84, s84, s85
    ds_write_b128 v14, v[20:23] offset:1024
    ds_read_b128 v[116:119], v15 offset:1024
    v_mfma_f32_16x16x32_bf16 v[232:235], v[40:43], v[100:103], v[232:235]
    v_pk_mul_f32 v[208:209], v[208:209], v[32:33]
    v_pk_mul_f32 v[210:211], v[210:211], v[34:35]
    v_pk_mul_f32 v[212:213], v[212:213], v[36:37]
    v_pk_mul_f32 v[214:215], v[214:215], v[38:39]
    v_mfma_f32_16x16x32_bf16 v[236:239], v[44:47], v[100:103], v[236:239]
    v_cvt_pk_bf16_f32 v24, v208, v209
    v_cvt_pk_bf16_f32 v25, v210, v211
    v_cvt_pk_bf16_f32 v26, v212, v213
    v_cvt_pk_bf16_f32 v27, v214, v215
    s_waitcnt lgkmcnt(4)
    buffer_store_dwordx4 v[124:127], v11, s[36:39], s84 offen sc1
    s_add_u32 s84, s84, s85
    ds_write_b128 v14, v[24:27] offset:2048
    ds_read_b128 v[120:123], v15 offset:2048
    v_mfma_f32_16x16x32_bf16 v[240:243], v[40:43], v[104:107], v[240:243]
    v_pk_mul_f32 v[216:217], v[216:217], v[32:33]
    v_pk_mul_f32 v[218:219], v[218:219], v[34:35]
    v_pk_mul_f32 v[220:221], v[220:221], v[36:37]
    v_pk_mul_f32 v[222:223], v[222:223], v[38:39]
    v_mfma_f32_16x16x32_bf16 v[244:247], v[44:47], v[104:107], v[244:247]
    v_cvt_pk_bf16_f32 v28, v216, v217
    v_cvt_pk_bf16_f32 v29, v218, v219
    v_cvt_pk_bf16_f32 v30, v220, v221
    v_cvt_pk_bf16_f32 v31, v222, v223
    s_waitcnt lgkmcnt(4)
    buffer_store_dwordx4 v[112:115], v11, s[36:39], s84 offen sc1
    s_add_u32 s84, s84, s85
    ds_write_b128 v14, v[28:31] offset:3072
    ds_read_b128 v[124:127], v15 offset:3072
    v_mfma_f32_16x16x32_bf16 v[248:251], v[40:43], v[108:111], v[248:251]
    v_pk_mul_f32 v[224:225], v[224:225], v[32:33]
    v_pk_mul_f32 v[226:227], v[226:227], v[34:35]
    v_pk_mul_f32 v[228:229], v[228:229], v[36:37]
    v_pk_mul_f32 v[230:231], v[230:231], v[38:39]
    v_mfma_f32_16x16x32_bf16 v[252:255], v[44:47], v[108:111], v[252:255]
    v_cvt_pk_bf16_f32 v16, v224, v225
    v_cvt_pk_bf16_f32 v17, v226, v227
    v_cvt_pk_bf16_f32 v18, v228, v229
    v_cvt_pk_bf16_f32 v19, v230, v231
    s_waitcnt lgkmcnt(4)
    buffer_store_dwordx4 v[116:119], v11, s[36:39], s84 offen sc1
    s_add_u32 s84, s84, s85
    ds_write_b128 v14, v[16:19] offset:0
    ds_read_b128 v[112:115], v15 offset:0
    v_pk_mul_f32 v[232:233], v[232:233], v[32:33]
    v_pk_mul_f32 v[234:235], v[234:235], v[34:35]
    v_pk_mul_f32 v[236:237], v[236:237], v[36:37]
    v_pk_mul_f32 v[238:239], v[238:239], v[38:39]
    v_cvt_pk_bf16_f32 v20, v232, v233
    v_cvt_pk_bf16_f32 v21, v234, v235
    v_cvt_pk_bf16_f32 v22, v236, v237
    v_cvt_pk_bf16_f32 v23, v238, v239
    s_waitcnt lgkmcnt(4)
    buffer_store_dwordx4 v[120:123], v11, s[36:39], s84 offen sc1
    s_add_u32 s84, s84, s85
    ds_write_b128 v14, v[20:23] offset:1024
    ds_read_b128 v[116:119], v15 offset:1024
    v_pk_mul_f32 v[240:241], v[240:241], v[32:33]
    v_pk_mul_f32 v[242:243], v[242:243], v[34:35]
    v_pk_mul_f32 v[244:245], v[244:245], v[36:37]
    v_pk_mul_f32 v[246:247], v[246:247], v[38:39]
    v_cvt_pk_bf16_f32 v24, v240, v241
    v_cvt_pk_bf16_f32 v25, v242, v243
    v_cvt_pk_bf16_f32 v26, v244, v245
    v_cvt_pk_bf16_f32 v27, v246, v247
    s_waitcnt lgkmcnt(4)
    buffer_store_dwordx4 v[124:127], v11, s[36:39], s84 offen sc1
    s_add_u32 s84, s84, s85
    ds_write_b128 v14, v[24:27] offset:2048
    ds_read_b128 v[120:123], v15 offset:2048
    v_pk_mul_f32 v[248:249], v[248:249], v[32:33]
    v_pk_mul_f32 v[250:251], v[250:251], v[34:35]
    v_pk_mul_f32 v[252:253], v[252:253], v[36:37]
    v_pk_mul_f32 v[254:255], v[254:255], v[38:39]
    v_cvt_pk_bf16_f32 v28, v248, v249
    v_cvt_pk_bf16_f32 v29, v250, v251
    v_cvt_pk_bf16_f32 v30, v252, v253
    v_cvt_pk_bf16_f32 v31, v254, v255
    s_waitcnt lgkmcnt(4)
    buffer_store_dwordx4 v[112:115], v11, s[36:39], s84 offen sc1
    s_add_u32 s84, s84, s85
    ds_write_b128 v14, v[28:31] offset:3072
    ds_read_b128 v[124:127], v15 offset:3072
    s_waitcnt lgkmcnt(4)
    buffer_store_dwordx4 v[116:119], v11, s[36:39], s84 offen sc1
    s_add_u32 s84, s84, s85
    s_waitcnt lgkmcnt(2)
    buffer_store_dwordx4 v[120:123], v11, s[36:39], s84 offen sc1
    s_add_u32 s84, s84, s85
    s_waitcnt lgkmcnt(0)
    buffer_store_dwordx4 v[124:127], v11, s[36:39], s84 offen sc1
    s_add_u32 s84, s84, s85
END_k1_kernel:
    s_endpgm
.globl k2_kernel
.p2align 8
.type k2_kernel,@function
k2_kernel:
    s_cmpk_ge_u32 s2, 256
    s_cbranch_scc1 END_k2_kernel
    s_load_dwordx2 s[24:25], s[0:1], 64
    v_lshrrev_b32 v4, 6, v0
    v_and_b32 v1, 63, v0
    v_readfirstlane_b32 s3, v4
    v_lshlrev_b32 v5, 4, v1
    s_mov_b32 s26, 0x2000000
    s_mov_b32 s27, 0x20000
    s_bfe_u32 s56, s2, 0x20001
    s_and_b32 s58, s2, 1
    s_lshr_b32 s59, s2, 5
    s_lshl3_add_u32 s58, s58, s59
    s_bfe_u32 s60, s2, 0x20003
    v_mov_b32 v6, 139264
    v_mov_b32 v8, 0
    v_and_b32 v9, 15, v0
    v_lshl_add_u32 v9, v9, 2, v6
    ds_write_b32 v9, v8
    s_waitcnt lgkmcnt(0)
    s_barrier
    s_cmp_lt_u32 s3, 2
    s_cbranch_scc1 FFT_WAVE
    s_cmp_lt_u32 s3, 6
    s_cbranch_scc1 GEMM_WAVE
    s_setprio 3
    s_and_b32 s54, s3, 1
    s_cmp_eq_u32 s54, 0
    s_cselect_b32 s61, s58, s60
    s_cselect_b32 s62, 0, 16777216
    s_mul_i32 s63, s56, 14
    s_mul_i32 s61, s61, 56
    s_add_u32 s61, s61, s63
    s_lshl_b32 s61, s61, 13
    s_add_u32 s61, s61, s62
    s_add_u32 s62, s61, 114688
    s_mul_i32 s63, s60, 7
    s_lshr_b32 s63, s63, 1
    s_mul_i32 s64, s59, 7
    s_lshr_b32 s64, s64, 2
    s_add_u32 s63, s63, s64
    s_mul_i32 s63, s63, 0
    s_cmp_ge_u32 s63, 14
    s_cselect_b32 s64, 14, 0
    s_sub_u32 s63, s63, s64
    s_mov_b32 s64, s61
    s_lshl_b32 s63, s63, 13
    s_add_u32 s61, s61, s63
    s_lshl_b32 s73, s54, 13
    s_mov_b32 s72, 0x1ffff
    v_add_u32 v7, 16, v6
    v_lshl_add_u32 v6, s54, 2, v6
    s_mov_b32 m0, s73
    s_addk_i32 s73, 0x1000
    buffer_load_dwordx4 v5, s[24:27], s61 offen offset:0 lds
    buffer_load_dwordx4 v5, s[24:27], s61 offen offset:1024 lds
    buffer_load_dwordx4 v5, s[24:27], s61 offen offset:2048 lds
    buffer_load_dwordx4 v5, s[24:27], s61 offen offset:3072 lds
    s_addk_i32 s61, 0x1000
    s_mov_b32 m0, s73
    s_addk_i32 s73, 0x3000
    buffer_load_dwordx4 v5, s[24:27], s61 offen offset:0 lds
    buffer_load_dwordx4 v5, s[24:27], s61 offen offset:1024 lds
    buffer_load_dwordx4 v5, s[24:27], s61 offen offset:2048 lds
    buffer_load_dwordx4 v5, s[24:27], s61 offen offset:3072 lds
    s_addk_i32 s61, 0x1000
    s_and_b32 s73, s73, s72
    s_cmp_eq_u32 s61, s62
    s_cselect_b32 s61, s64, s61
    s_mov_b32 m0, s73
    s_addk_i32 s73, 0x1000
    buffer_load_dwordx4 v5, s[24:27], s61 offen offset:0 lds
    buffer_load_dwordx4 v5, s[24:27], s61 offen offset:1024 lds
    buffer_load_dwordx4 v5, s[24:27], s61 offen offset:2048 lds
    buffer_load_dwordx4 v5, s[24:27], s61 offen offset:3072 lds
    s_addk_i32 s61, 0x1000
    s_mov_b32 m0, s73
    s_addk_i32 s73, 0x3000
    buffer_load_dwordx4 v5, s[24:27], s61 offen offset:0 lds
    buffer_load_dwordx4 v5, s[24:27], s61 offen offset:1024 lds
    buffer_load_dwordx4 v5, s[24:27], s61 offen offset:2048 lds
    buffer_load_dwordx4 v5, s[24:27], s61 offen offset:3072 lds
    s_addk_i32 s61, 0x1000
    s_and_b32 s73, s73, s72
    s_cmp_eq_u32 s61, s62
    s_cselect_b32 s61, s64, s61
    s_waitcnt vmcnt(8)
    v_mov_b32 v12, 1
    ds_write_b32 v6, v12
    s_mov_b32 m0, s73
    s_addk_i32 s73, 0x1000
    buffer_load_dwordx4 v5, s[24:27], s61 offen offset:0 lds
    buffer_load_dwordx4 v5, s[24:27], s61 offen offset:1024 lds
    buffer_load_dwordx4 v5, s[24:27], s61 offen offset:2048 lds
    buffer_load_dwordx4 v5, s[24:27], s61 offen offset:3072 lds
    s_addk_i32 s61, 0x1000
    s_mov_b32 m0, s73
    s_addk_i32 s73, 0x3000
    buffer_load_dwordx4 v5, s[24:27], s61 offen offset:0 lds
    buffer_load_dwordx4 v5, s[24:27], s61 offen offset:1024 lds
    buffer_load_dwordx4 v5, s[24:27], s61 offen offset:2048 lds
    buffer_load_dwordx4 v5, s[24:27], s61 offen offset:3072 lds
    s_addk_i32 s61, 0x1000
    s_and_b32 s73, s73, s72
    s_cmp_eq_u32 s61, s62
    s_cselect_b32 s61, s64, s61
    s_mov_b32 s78, 2
    s_mov_b32 s79, -4
K2L_LOOP:
    s_cmp_lt_i32 s79, 1
    s_cbranch_scc1 FREE1_k2_kernel
SPL2_k2_kernel:
    ds_read_b128 v[8:11], v7 offset:0
    s_waitcnt lgkmcnt(0)
    v_min_u32 v8, v8, v9
    v_min3_u32 v8, v8, v10, v11
    s_nop 0
    v_readfirstlane_b32 s52, v8
    s_nop 2
    s_cmp_lt_u32 s52, s79
    s_cbranch_scc1 SPL2_k2_kernel
FREE1_k2_kernel:
    s_mov_b32 m0, s73
    s_addk_i32 s73, 0x1000
    buffer_load_dwordx4 v5, s[24:27], s61 offen offset:0 lds
    buffer_load_dwordx4 v5, s[24:27], s61 offen offset:1024 lds
    buffer_load_dwordx4 v5, s[24:27], s61 offen offset:2048 lds
    buffer_load_dwordx4 v5, s[24:27], s61 offen offset:3072 lds
    s_addk_i32 s61, 0x1000
    s_mov_b32 m0, s73
    s_addk_i32 s73, 0x3000
    buffer_load_dwordx4 v5, s[24:27], s61 offen offset:0 lds
    buffer_load_dwordx4 v5, s[24:27], s61 offen offset:1024 lds
    buffer_load_dwordx4 v5, s[24:27], s61 offen offset:2048 lds
    buffer_load_dwordx4 v5, s[24:27], s61 offen offset:3072 lds
    s_addk_i32 s61, 0x1000
    s_and_b32 s73, s73, s72
    s_cmp_eq_u32 s61, s62
    s_cselect_b32 s61, s64, s61
    s_waitcnt vmcnt(16)
    v_mov_b32 v12, s78
    ds_write_b32 v6, v12
    s_add_u32 s78, s78, 1
    s_add_u32 s79, s79, 1
    s_cmp_lt_u32 s78, 13
    s_cbranch_scc1 K2L_LOOP
    s_waitcnt vmcnt(8)
    v_mov_b32 v12, 13
    ds_write_b32 v6, v12
    s_waitcnt vmcnt(0)
    v_mov_b32 v13, 14
    ds_write_b32 v6, v13
    s_endpgm
GEMM_WAVE:
    s_setprio 2
    s_sub_u32 s3, s3, 2
    s_and_b32 s54, s3, 1
    s_lshr_b32 s55, s3, 1
    s_lshl_b32 s63, s54, 12
    v_add_u32 v8, s63, v5
    s_lshl_b32 s63, s55, 12
    s_addk_i32 s63, 0x2000
    v_add_u32 v9, s63, v5
    s_lshl_b32 s63, s3, 2
    s_add_u32 s63, s63, 139280
    v_mov_b32 v7, s63
    s_lshl1_add_u32 s63, s58, s54
    s_lshl_b32 s64, s56, 5
    s_add_u32 s63, s63, s64
    s_lshl1_add_u32 s64, s60, s55
    s_lshl3_add_u32 s63, s63, s64
    s_lshl_b32 s63, s63, 13
    s_add_u32 s61, s63, 20971520
    s_add_u32 s62, s61, 0x1000
    s_mov_b32 s71, 0x8000
    s_mov_b32 s72, 0x1ffff
    s_mov_b32 s78, 1
    v_pk_mov_b32 v[32:33], 0, 0
    v_pk_mov_b32 v[34:35], 0, 0
    v_pk_mov_b32 v[36:37], 0, 0
    v_pk_mov_b32 v[38:39], 0, 0
    v_pk_mov_b32 v[40:41], 0, 0
    v_pk_mov_b32 v[42:43], 0, 0
    v_pk_mov_b32 v[44:45], 0, 0
    v_pk_mov_b32 v[46:47], 0, 0
    v_pk_mov_b32 v[48:49], 0, 0
    v_pk_mov_b32 v[50:51], 0, 0
    v_pk_mov_b32 v[52:53], 0, 0
    v_pk_mov_b32 v[54:55], 0, 0
    v_pk_mov_b32 v[56:57], 0, 0
    v_pk_mov_b32 v[58:59], 0, 0
    v_pk_mov_b32 v[60:61], 0, 0
    v_pk_mov_b32 v[62:63], 0, 0
    v_pk_mov_b32 v[64:65], 0, 0
    v_pk_mov_b32 v[66:67], 0, 0
    v_pk_mov_b32 v[68:69], 0, 0
    v_pk_mov_b32 v[70:71], 0, 0
    v_pk_mov_b32 v[72:73], 0, 0
    v_pk_mov_b32 v[74:75], 0, 0
    v_pk_mov_b32 v[76:77], 0, 0
    v_pk_mov_b32 v[78:79], 0, 0
    v_pk_mov_b32 v[80:81], 0, 0
    v_pk_mov_b32 v[82:83], 0, 0
    v_pk_mov_b32 v[84:85], 0, 0
    v_pk_mov_b32 v[86:87], 0, 0
    v_pk_mov_b32 v[88:89], 0, 0
    v_pk_mov_b32 v[90:91], 0, 0
    v_pk_mov_b32 v[92:93], 0, 0
    v_pk_mov_b32 v[94:95], 0, 0
    s_branch SPG5_k2_kernel
SPG4_k2_kernel:
    s_sleep 1
SPG5_k2_kernel:
    ds_read_b64 v[12:13], v6 offset:0
    s_waitcnt lgkmcnt(0)
    v_min_u32 v12, v12, v13
    s_nop 0
    v_readfirstlane_b32 s52, v12
    s_nop 2
    s_cmp_lt_u32 s52, 1
    s_cbranch_scc1 SPG4_k2_kernel
    ds_read_b128 v[112:115], v9 offset:0
    ds_read_b128 v[96:99], v8 offset:0
    ds_read_b128 v[100:103], v8 offset:1024
    ds_read_b128 v[104:107], v8 offset:2048
    ds_read_b128 v[108:111], v8 offset:3072
    ds_read_b128 v[116:119], v9 offset:1024
    ds_read_b128 v[120:123], v9 offset:2048
    ds_read_b128 v[124:127], v9 offset:3072
    ds_read_b64 v[12:13], v6
K2G_LOOP:
    s_waitcnt lgkmcnt(7)
    v_mfma_f32_16x16x32_bf16 v[32:35], v[112:115], v[96:99], v[32:35]
    v_mov_b32 v11, s78
    s_add_u32 s78, s78, 1
    s_min_u32 s79, s78, 14
    s_waitcnt lgkmcnt(6)
    v_mfma_f32_16x16x32_bf16 v[36:39], v[112:115], v[100:103], v[36:39]
    s_waitcnt lgkmcnt(5)
    v_mfma_f32_16x16x32_bf16 v[40:43], v[112:115], v[104:107], v[40:43]
    s_waitcnt lgkmcnt(4)
    v_mfma_f32_16x16x32_bf16 v[44:47], v[112:115], v[108:111], v[44:47]
    s_waitcnt lgkmcnt(3)
    v_mfma_f32_16x16x32_bf16 v[48:51], v[116:119], v[96:99], v[48:51]
    s_waitcnt lgkmcnt(0)
    v_min_u32 v12, v12, v13
    ds_write_b32 v7, v11
    v_mfma_f32_16x16x32_bf16 v[52:55], v[116:119], v[100:103], v[52:55]
    v_readfirstlane_b32 s52, v12
    v_mfma_f32_16x16x32_bf16 v[56:59], v[116:119], v[104:107], v[56:59]
    s_nop 1
    s_cmp_lt_u32 s52, s79
    s_cbranch_scc1 SLOW6_k2_kernel
BACK7_k2_kernel:
    ds_read_b128 v[144:147], v9 offset:16384
    v_mfma_f32_16x16x32_bf16 v[60:63], v[116:119], v[108:111], v[60:63]
    ds_read_b128 v[128:131], v8 offset:16384
    v_mfma_f32_16x16x32_bf16 v[64:67], v[120:123], v[96:99], v[64:67]
    ds_read_b128 v[132:135], v8 offset:17408
    v_mfma_f32_16x16x32_bf16 v[68:71], v[120:123], v[100:103], v[68:71]
    ds_read_b128 v[136:139], v8 offset:18432
    v_mfma_f32_16x16x32_bf16 v[72:75], v[120:123], v[104:107], v[72:75]
    ds_read_b128 v[140:143], v8 offset:19456
    v_mfma_f32_16x16x32_bf16 v[76:79], v[120:123], v[108:111], v[76:79]
    ds_read_b128 v[148:151], v9 offset:17408
    v_mfma_f32_16x16x32_bf16 v[80:83], v[124:127], v[96:99], v[80:83]
    ds_read_b128 v[152:155], v9 offset:18432
    v_mfma_f32_16x16x32_bf16 v[84:87], v[124:127], v[100:103], v[84:87]
    ds_read_b128 v[156:159], v9 offset:19456
    v_mfma_f32_16x16x32_bf16 v[88:91], v[124:127], v[104:107], v[88:91]
    ds_read_b64 v[12:13], v6
    v_mfma_f32_16x16x32_bf16 v[92:95], v[124:127], v[108:111], v[92:95]
    s_waitcnt lgkmcnt(7)
    v_mfma_f32_16x16x32_bf16 v[32:35], v[144:147], v[128:131], v[32:35]
    v_mov_b32 v11, s78
    s_add_u32 s78, s78, 1
    s_min_u32 s79, s78, 14
    s_waitcnt lgkmcnt(6)
    v_mfma_f32_16x16x32_bf16 v[36:39], v[144:147], v[132:135], v[36:39]
    v_add_u32 v8, s71, v8
    v_add_u32 v9, s71, v9
    s_waitcnt lgkmcnt(5)
    v_mfma_f32_16x16x32_bf16 v[40:43], v[144:147], v[136:139], v[40:43]
    v_and_b32 v8, s72, v8
    v_and_b32 v9, s72, v9
    s_waitcnt lgkmcnt(4)
    v_mfma_f32_16x16x32_bf16 v[44:47], v[144:147], v[140:143], v[44:47]
    s_waitcnt lgkmcnt(3)
    v_mfma_f32_16x16x32_bf16 v[48:51], v[148:151], v[128:131], v[48:51]
    s_waitcnt lgkmcnt(0)
    v_min_u32 v12, v12, v13
    ds_write_b32 v7, v11
    v_mfma_f32_16x16x32_bf16 v[52:55], v[148:151], v[132:135], v[52:55]
    v_readfirstlane_b32 s52, v12
    v_mfma_f32_16x16x32_bf16 v[56:59], v[148:151], v[136:139], v[56:59]
    s_nop 1
    s_cmp_lt_u32 s52, s79
    s_cbranch_scc1 SLOW8_k2_kernel
BACK9_k2_kernel:
    ds_read_b128 v[112:115], v9 offset:0
    v_mfma_f32_16x16x32_bf16 v[60:63], v[148:151], v[140:143], v[60:63]
    ds_read_b128 v[96:99], v8 offset:0
    v_mfma_f32_16x16x32_bf16 v[64:67], v[152:155], v[128:131], v[64:67]
    ds_read_b128 v[100:103], v8 offset:1024
    v_mfma_f32_16x16x32_bf16 v[68:71], v[152:155], v[132:135], v[68:71]
    ds_read_b128 v[104:107], v8 offset:2048
    v_mfma_f32_16x16x32_bf16 v[72:75], v[152:155], v[136:139], v[72:75]
    ds_read_b128 v[108:111], v8 offset:3072
    v_mfma_f32_16x16x32_bf16 v[76:79], v[152:155], v[140:143], v[76:79]
    ds_read_b128 v[116:119], v9 offset:1024
    v_mfma_f32_16x16x32_bf16 v[80:83], v[156:159], v[128:131], v[80:83]
    ds_read_b128 v[120:123], v9 offset:2048
    v_mfma_f32_16x16x32_bf16 v[84:87], v[156:159], v[132:135], v[84:87]
    ds_read_b128 v[124:127], v9 offset:3072
    v_mfma_f32_16x16x32_bf16 v[88:91], v[156:159], v[136:139], v[88:91]
    ds_read_b64 v[12:13], v6
    v_mfma_f32_16x16x32_bf16 v[92:95], v[156:159], v[140:143], v[92:95]
    s_cmp_lt_u32 s78, 15
    s_cbranch_scc1 K2G_LOOP
    s_waitcnt lgkmcnt(7)
    v_cvt_pk_bf16_f32 v96, v32, v33
    v_cvt_pk_bf16_f32 v97, v34, v35
    v_cvt_pk_bf16_f32 v98, v36, v37
    v_cvt_pk_bf16_f32 v99, v38, v39
    buffer_store_dwordx4 v[96:99], v5, s[24:27], s61 offen offset:0 sc1
    s_waitcnt lgkmcnt(6)
    v_cvt_pk_bf16_f32 v100, v40, v41
    v_cvt_pk_bf16_f32 v101, v42, v43
    v_cvt_pk_bf16_f32 v102, v44, v45
    v_cvt_pk_bf16_f32 v103, v46, v47
    buffer_store_dwordx4 v[100:103], v5, s[24:27], s61 offen offset:1024 sc1
    s_waitcnt lgkmcnt(5)
    v_cvt_pk_bf16_f32 v104, v48, v49
    v_cvt_pk_bf16_f32 v105, v50, v51
    v_cvt_pk_bf16_f32 v106, v52, v53
    v_cvt_pk_bf16_f32 v107, v54, v55
    buffer_store_dwordx4 v[104:107], v5, s[24:27], s61 offen offset:2048 sc1
    s_waitcnt lgkmcnt(4)
    v_cvt_pk_bf16_f32 v108, v56, v57
    v_cvt_pk_bf16_f32 v109, v58, v59
    v_cvt_pk_bf16_f32 v110, v60, v61
    v_cvt_pk_bf16_f32 v111, v62, v63
    buffer_store_dwordx4 v[108:111], v5, s[24:27], s61 offen offset:3072 sc1
    v_cvt_pk_bf16_f32 v112, v64, v65
    v_cvt_pk_bf16_f32 v113, v66, v67
    v_cvt_pk_bf16_f32 v114, v68, v69
    v_cvt_pk_bf16_f32 v115, v70, v71
    buffer_store_dwordx4 v[112:115], v5, s[24:27], s62 offen offset:0 sc1
    s_waitcnt lgkmcnt(3)
    v_cvt_pk_bf16_f32 v116, v72, v73
    v_cvt_pk_bf16_f32 v117, v74, v75
    v_cvt_pk_bf16_f32 v118, v76, v77
    v_cvt_pk_bf16_f32 v119, v78, v79
    buffer_store_dwordx4 v[116:119], v5, s[24:27], s62 offen offset:1024 sc1
    s_waitcnt lgkmcnt(2)
    v_cvt_pk_bf16_f32 v120, v80, v81
    v_cvt_pk_bf16_f32 v121, v82, v83
    v_cvt_pk_bf16_f32 v122, v84, v85
    v_cvt_pk_bf16_f32 v123, v86, v87
    buffer_store_dwordx4 v[120:123], v5, s[24:27], s62 offen offset:2048 sc1
    s_waitcnt lgkmcnt(1)
    v_cvt_pk_bf16_f32 v124, v88, v89
    v_cvt_pk_bf16_f32 v125, v90, v91
    v_cvt_pk_bf16_f32 v126, v92, v93
    v_cvt_pk_bf16_f32 v127, v94, v95
    buffer_store_dwordx4 v[124:127], v5, s[24:27], s62 offen offset:3072 sc1
    s_endpgm
SLOW6_k2_kernel:
    s_sleep 1
    ds_read_b64 v[12:13], v6
    s_waitcnt lgkmcnt(0)
    v_min_u32 v12, v12, v13
    s_nop 0
    v_readfirstlane_b32 s52, v12
    s_nop 3
    s_cmp_lt_u32 s52, s79
    s_cbranch_scc1 SLOW6_k2_kernel
    s_branch BACK7_k2_kernel
SLOW8_k2_kernel:
    s_sleep 1
    ds_read_b64 v[12:13], v6
    s_waitcnt lgkmcnt(0)
    v_min_u32 v12, v12, v13
    s_nop 0
    v_readfirstlane_b32 s52, v12
    s_nop 3
    s_cmp_lt_u32 s52, s79
    s_cbranch_scc1 SLOW8_k2_kernel
    s_branch BACK9_k2_kernel
FFT_WAVE:
    s_setprio 1
    s_lshl_b32 s61, s2, 13
    s_add_u32 s62, s61, 8388608
    s_add_u32 s63, s62, 0x1000
    s_getpc_b64 s[28:29]
    s_add_u32 s28, s28, CTAB@rel32@lo+4
    s_addc_u32 s29, s29, CTAB@rel32@hi+12
    s_movk_i32 s30, 0x4000
    s_mov_b32 s31, 0x20000
    s_lshl_b32 s66, s3, 10
    s_add_u32 s67, s66, 0x3000
    s_cmpk_eq_u32 s2, 255
    s_cselect_b32 s67, s66, s67
    s_add_u32 s64, s61, s66
    s_add_u32 s64, s64, 10485760
    s_add_u32 s65, s64, 0x1000
    v_and_b32 v7, 60, v1
    v_lshlrev_b32 v7, 5, v7
    v_and_b32 v4, 3, v1
    v_lshl_or_b32 v7, v4, 4, v7
    s_movk_i32 s68, 0x1000
    s_movk_i32 s69, 0x2000
    s_setprio 0
    v_lshrrev_b32 v2, 4, v1
    v_and_b32 v3, 15, v1
    s_lshl_b32 s70, s3, 4
    v_add_u32 v8, s70, v3
    v_cvt_f32_u32 v8, v8
    v_mul_f32 v8, 0x3a000000, v8
    v_mul_f32 v9, 0x41500000, v8
    v_lshlrev_b32 v10, 2, v2
    v_cvt_f32_u32 v11, v10
    v_mul_f32 v11, v11, v8
    s_mov_b32 s71, 0x80008000
    s_mov_b32 s72, 0xffff0000
    v_cos_f32 v176, v11
    v_sin_f32 v177, v11
    v_add_f32 v11, v11, v8
    v_cos_f32 v178, v11
    v_sin_f32 v179, v11
    v_add_f32 v11, v11, v8
    v_cos_f32 v180, v11
    v_sin_f32 v181, v11
    v_add_f32 v11, v11, v8
    v_cos_f32 v182, v11
    v_sin_f32 v183, v11
    v_add_f32 v11, v11, v9
    v_cos_f32 v184, v11
    v_sin_f32 v185, v11
    v_add_f32 v11, v11, v8
    v_cos_f32 v186, v11
    v_sin_f32 v187, v11
    v_add_f32 v11, v11, v8
    v_cos_f32 v188, v11
    v_sin_f32 v189, v11
    v_add_f32 v11, v11, v8
    v_cos_f32 v190, v11
    v_sin_f32 v191, v11
    v_add_f32 v11, v11, v9
    buffer_load_dwordx4 v[72:75], v7, s[24:27], s62 offen offset:0
    buffer_load_dwordx4 v[76:79], v7, s[24:27], s62 offen offset:2048
    buffer_load_dwordx4 v[80:83], v7, s[24:27], s63 offen offset:0
    buffer_load_dwordx4 v[84:87], v7, s[24:27], s63 offen offset:2048
    buffer_load_dwordx4 v[88:91], v7, s[24:27], s62 offen offset:64
    buffer_load_dwordx4 v[92:95], v7, s[24:27], s62 offen offset:2112
    buffer_load_dwordx4 v[96:99], v7, s[24:27], s63 offen offset:64
    buffer_load_dwordx4 v[100:103], v7, s[24:27], s63 offen offset:2112
    buffer_load_dwordx4 v[64:67], v5, s[28:31], s67 offen offset:0
    buffer_load_dwordx4 v[68:71], v5, s[28:31], s67 offen offset:2048
    v_cos_f32 v192, v11
    v_sin_f32 v193, v11
    v_add_f32 v11, v11, v8
    v_cos_f32 v194, v11
    v_sin_f32 v195, v11
    v_add_f32 v11, v11, v8
    v_cos_f32 v196, v11
    v_sin_f32 v197, v11
    v_add_f32 v11, v11, v8
    v_cos_f32 v198, v11
    v_sin_f32 v199, v11
    v_add_f32 v11, v11, v9
    v_cos_f32 v200, v11
    v_sin_f32 v201, v11
    v_add_f32 v11, v11, v8
    v_cos_f32 v202, v11
    v_sin_f32 v203, v11
    v_add_f32 v11, v11, v8
    v_cos_f32 v204, v11
    v_sin_f32 v205, v11
    v_add_f32 v11, v11, v8
    v_cos_f32 v206, v11
    v_sin_f32 v207, v11
    buffer_load_dwordx4 v[16:19], v5, s[28:31], 0 offen offset:0
    buffer_load_dwordx4 v[20:23], v5, s[28:31], 0 offen offset:1024
    buffer_load_dwordx4 v[24:27], v5, s[28:31], 0 offen offset:2048
    buffer_load_dwordx4 v[28:31], v5, s[28:31], 0 offen offset:3072
    buffer_load_dwordx4 v[32:35], v5, s[28:31], s68 offen offset:0
    buffer_load_dwordx4 v[36:39], v5, s[28:31], s68 offen offset:1024
    buffer_load_dwordx4 v[40:43], v5, s[28:31], s68 offen offset:2048
    buffer_load_dwordx4 v[44:47], v5, s[28:31], s68 offen offset:3072
    v_add_u32 v10, s70, v10
    v_cvt_f32_u32 v10, v10
    v_cvt_f32_u32 v12, v3
    s_lshl_b32 s73, s3, 5
    s_xor_b32 s74, s73, 32
    v_cvt_f32_u32 v13, s73
    v_cvt_f32_u32 v14, s74
    v_add_f32 v13, v13, v12
    v_add_f32 v14, v14, v12
    v_mul_f32 v13, 0x3a000000, v13
    v_mul_f32 v14, 0x3a000000, v14
    s_lshl_b32 s75, s3, 31
    s_or_b32 s75, s75, 1.0
    s_xor_b32 s76, s75, 0x80000000
    s_mul_i32 s77, s3, 0x1008
    s_add_u32 s77, s77, 131072
    v_add_u32 v8, s77, v5
    v_xor_b32 v9, 0x1000, v8
    v_and_b32 v12, -9, v8
    s_lshl_b32 s77, s3, 2
    s_add_u32 s77, s77, 139296
    v_mov_b32 v15, s77
    v_xor_b32 v7, 4, v15
    v_lshlrev_b32 v4, 9, v2
    v_lshl_add_u32 v4, v3, 4, v4
    s_lshl_b32 s77, s3, 12
    s_add_u32 s62, s61, s77
    s_add_u32 s62, s62, 12582912
    s_add_u32 s63, s62, 0x1000
    s_waitcnt vmcnt(17)
    v_xor_b32 v104, s71, v72
    v_xor_b32 v105, s71, v73
    v_xor_b32 v106, s71, v74
    v_xor_b32 v107, s71, v75
    s_waitcnt vmcnt(16)
    v_xor_b32 v108, s71, v76
    v_xor_b32 v109, s71, v77
    v_xor_b32 v110, s71, v78
    v_xor_b32 v111, s71, v79
    s_waitcnt vmcnt(15)
    v_xor_b32 v112, s71, v80
    v_xor_b32 v113, s71, v81
    v_xor_b32 v114, s71, v82
    v_xor_b32 v115, s71, v83
    s_waitcnt vmcnt(14)
    v_xor_b32 v116, s71, v84
    v_xor_b32 v117, s71, v85
    v_xor_b32 v118, s71, v86
    v_xor_b32 v119, s71, v87
    s_waitcnt vmcnt(9)
    v_mfma_f32_16x16x32_bf16 v[120:123], v[72:75], v[64:67], 0
    v_mfma_f32_16x16x32_bf16 v[124:127], v[88:91], v[64:67], 0
    s_waitcnt vmcnt(8)
    v_mfma_f32_16x16x32_bf16 v[120:123], v[88:91], v[68:71], v[120:123]
    v_mfma_f32_16x16x32_bf16 v[124:127], v[104:107], v[68:71], v[124:127]
    v_mfma_f32_16x16x32_bf16 v[128:131], v[76:79], v[64:67], 0
    v_mfma_f32_16x16x32_bf16 v[132:135], v[92:95], v[64:67], 0
    v_mfma_f32_16x16x32_bf16 v[128:131], v[92:95], v[68:71], v[128:131]
    v_mfma_f32_16x16x32_bf16 v[132:135], v[108:111], v[68:71], v[132:135]
    v_mfma_f32_16x16x32_bf16 v[136:139], v[80:83], v[64:67], 0
    v_mfma_f32_16x16x32_bf16 v[140:143], v[96:99], v[64:67], 0
    v_mfma_f32_16x16x32_bf16 v[136:139], v[96:99], v[68:71], v[136:139]
    v_mfma_f32_16x16x32_bf16 v[140:143], v[112:115], v[68:71], v[140:143]
    v_mfma_f32_16x16x32_bf16 v[144:147], v[84:87], v[64:67], 0
    v_mfma_f32_16x16x32_bf16 v[148:151], v[100:103], v[64:67], 0
    v_mfma_f32_16x16x32_bf16 v[144:147], v[100:103], v[68:71], v[144:147]
    v_mfma_f32_16x16x32_bf16 v[148:151], v[116:119], v[68:71], v[148:151]
    buffer_load_dwordx4 v[208:211], v5, s[24:27], s64 offen offset:0
    buffer_load_dwordx4 v[212:215], v5, s[24:27], s64 offen offset:2048
    buffer_load_dwordx4 v[216:219], v5, s[24:27], s65 offen offset:0
    buffer_load_dwordx4 v[220:223], v5, s[24:27], s65 offen offset:2048
    buffer_load_dwordx4 v[48:51], v5, s[28:31], s69 offen offset:0
    buffer_load_dwordx4 v[52:55], v5, s[28:31], s69 offen offset:1024
    buffer_load_dwordx4 v[56:59], v5, s[28:31], s69 offen offset:2048
    buffer_load_dwordx4 v[60:63], v5, s[28:31], s69 offen offset:3072
    v_mul_f32 v224, v120, v177
    v_mul_f32 v120, v120, v176
    v_mul_f32 v225, v121, v179
    v_mul_f32 v121, v121, v178
    v_mul_f32 v226, v122, v181
    v_mul_f32 v122, v122, v180
    v_mul_f32 v227, v123, v183
    v_mul_f32 v123, v123, v182
    v_fmac_f32 v120, v124, v177
    v_fma_f32 v124, v124, v176, -v224
    v_fmac_f32 v121, v125, v179
    v_fma_f32 v125, v125, v178, -v225
    v_fmac_f32 v122, v126, v181
    v_fma_f32 v126, v126, v180, -v226
    v_fmac_f32 v123, v127, v183
    v_fma_f32 v127, v127, v182, -v227
    v_mul_f32 v224, v128, v185
    v_mul_f32 v128, v128, v184
    v_mul_f32 v225, v129, v187
    v_mul_f32 v129, v129, v186
    v_mul_f32 v226, v130, v189
    v_mul_f32 v130, v130, v188
    v_mul_f32 v227, v131, v191
    v_mul_f32 v131, v131, v190
    v_fmac_f32 v128, v132, v185
    v_fma_f32 v132, v132, v184, -v224
    v_fmac_f32 v129, v133, v187
    v_fma_f32 v133, v133, v186, -v225
    v_fmac_f32 v130, v134, v189
    v_fma_f32 v134, v134, v188, -v226
    v_fmac_f32 v131, v135, v191
    v_fma_f32 v135, v135, v190, -v227
    v_mul_f32 v224, v136, v193
    v_mul_f32 v136, v136, v192
    v_mul_f32 v225, v137, v195
    v_mul_f32 v137, v137, v194
    v_mul_f32 v226, v138, v197
    v_mul_f32 v138, v138, v196
    v_mul_f32 v227, v139, v199
    v_mul_f32 v139, v139, v198
    v_fmac_f32 v136, v140, v193
    v_fma_f32 v140, v140, v192, -v224
    v_fmac_f32 v137, v141, v195
    v_fma_f32 v141, v141, v194, -v225
    v_fmac_f32 v138, v142, v197
    v_fma_f32 v142, v142, v196, -v226
    v_fmac_f32 v139, v143, v199
    v_fma_f32 v143, v143, v198, -v227
    v_mul_f32 v224, v144, v201
    v_mul_f32 v144, v144, v200
    v_mul_f32 v225, v145, v203
    v_mul_f32 v145, v145, v202
    v_mul_f32 v226, v146, v205
    v_mul_f32 v146, v146, v204
    v_mul_f32 v227, v147, v207
    v_mul_f32 v147, v147, v206
    v_fmac_f32 v144, v148, v201
    v_fma_f32 v148, v148, v200, -v224
    v_fmac_f32 v145, v149, v203
    v_fma_f32 v149, v149, v202, -v225
    v_fmac_f32 v146, v150, v205
    v_fma_f32 v150, v150, v204, -v226
    v_fmac_f32 v147, v151, v207
    v_fma_f32 v151, v151, v206, -v227
    v_add_f32 v228, v120, v136
    v_add_f32 v229, v121, v137
    v_sub_f32 v136, v120, v136
    v_sub_f32 v137, v121, v137
    v_cvt_pk_bf16_f32 v152, v228, v229
    v_cvt_pk_bf16_f32 v164, v136, v137
    v_add_f32 v230, v122, v138
    v_add_f32 v231, v123, v139
    v_sub_f32 v138, v122, v138
    v_sub_f32 v139, v123, v139
    v_cvt_pk_bf16_f32 v153, v230, v231
    v_cvt_pk_bf16_f32 v165, v138, v139
    v_add_f32 v228, v128, v144
    v_add_f32 v229, v129, v145
    v_sub_f32 v144, v128, v144
    v_sub_f32 v145, v129, v145
    v_cvt_pk_bf16_f32 v154, v228, v229
    v_cvt_pk_bf16_f32 v166, v144, v145
    v_add_f32 v230, v130, v146
    v_add_f32 v231, v131, v147
    v_sub_f32 v146, v130, v146
    v_sub_f32 v147, v131, v147
    v_cvt_pk_bf16_f32 v155, v230, v231
    v_cvt_pk_bf16_f32 v167, v146, v147
    v_add_f32 v228, v124, v140
    v_add_f32 v229, v125, v141
    v_sub_f32 v140, v124, v140
    v_sub_f32 v141, v125, v141
    v_cvt_pk_bf16_f32 v156, v228, v229
    v_cvt_pk_bf16_f32 v168, v140, v141
    v_add_f32 v230, v126, v142
    v_add_f32 v231, v127, v143
    v_sub_f32 v142, v126, v142
    v_sub_f32 v143, v127, v143
    v_cvt_pk_bf16_f32 v157, v230, v231
    v_cvt_pk_bf16_f32 v169, v142, v143
    v_add_f32 v228, v132, v148
    v_add_f32 v229, v133, v149
    v_sub_f32 v148, v132, v148
    v_sub_f32 v149, v133, v149
    v_cvt_pk_bf16_f32 v158, v228, v229
    v_cvt_pk_bf16_f32 v170, v148, v149
    v_add_f32 v230, v134, v150
    v_add_f32 v231, v135, v151
    v_sub_f32 v150, v134, v150
    v_sub_f32 v151, v135, v151
    v_cvt_pk_bf16_f32 v159, v230, v231
    v_cvt_pk_bf16_f32 v171, v150, v151
    v_xor_b32 v160, s71, v152
    v_xor_b32 v161, s71, v153
    v_xor_b32 v162, s71, v154
    v_xor_b32 v163, s71, v155
    v_xor_b32 v172, s71, v164
    v_xor_b32 v173, s71, v165
    v_xor_b32 v174, s71, v166
    v_xor_b32 v175, s71, v167
    s_waitcnt vmcnt(15)
    v_mfma_f32_16x16x32_bf16 v[120:123], v[16:19], v[152:155], 0
    v_mul_f32 v11, v10, v13
    v_cos_f32 v176, v11
    v_mfma_f32_16x16x32_bf16 v[124:127], v[16:19], v[156:159], 0
    v_sin_f32 v177, v11
    v_add_f32 v11, v11, v13
    s_waitcnt vmcnt(13)
    v_mfma_f32_16x16x32_bf16 v[120:123], v[24:27], v[156:159], v[120:123]
    v_cos_f32 v178, v11
    v_sin_f32 v179, v11
    v_mfma_f32_16x16x32_bf16 v[124:127], v[24:27], v[160:163], v[124:127]
    v_add_f32 v11, v11, v13
    v_cos_f32 v180, v11
    v_mfma_f32_16x16x32_bf16 v[128:131], v[20:23], v[152:155], 0
    v_sin_f32 v181, v11
    v_add_f32 v11, v11, v13
    v_mfma_f32_16x16x32_bf16 v[132:135], v[20:23], v[156:159], 0
    v_cos_f32 v182, v11
    v_sin_f32 v183, v11
    s_waitcnt vmcnt(12)
    v_mfma_f32_16x16x32_bf16 v[128:131], v[28:31], v[156:159], v[128:131]
    v_add_f32 v13, 0x3c000000, v13
    v_mul_f32 v11, v10, v13
    v_mfma_f32_16x16x32_bf16 v[132:135], v[28:31], v[160:163], v[132:135]
    v_cos_f32 v184, v11
    v_sin_f32 v185, v11
    s_waitcnt vmcnt(11)
    v_mfma_f32_16x16x32_bf16 v[136:139], v[32:35], v[164:167], 0
    v_add_f32 v11, v11, v13
    v_cos_f32 v186, v11
    v_mfma_f32_16x16x32_bf16 v[140:143], v[32:35], v[168:171], 0
    v_sin_f32 v187, v11
    v_add_f32 v11, v11, v13
    s_waitcnt vmcnt(9)
    v_mfma_f32_16x16x32_bf16 v[136:139], v[40:43], v[168:171], v[136:139]
    v_cos_f32 v188, v11
    v_sin_f32 v189, v11
    v_mfma_f32_16x16x32_bf16 v[140:143], v[40:43], v[172:175], v[140:143]
    v_add_f32 v11, v11, v13
    v_cos_f32 v190, v11
    v_mfma_f32_16x16x32_bf16 v[144:147], v[36:39], v[164:167], 0
    v_sin_f32 v191, v11
    v_mul_f32 v11, v10, v14
    v_mfma_f32_16x16x32_bf16 v[148:151], v[36:39], v[168:171], 0
    v_cos_f32 v192, v11
    v_sin_f32 v193, v11
    s_waitcnt vmcnt(8)
    v_mfma_f32_16x16x32_bf16 v[144:147], v[44:47], v[168:171], v[144:147]
    v_add_f32 v11, v11, v14
    v_cos_f32 v194, v11
    v_mfma_f32_16x16x32_bf16 v[148:151], v[44:47], v[172:175], v[148:151]
    v_sin_f32 v195, v11
    v_add_f32 v11, v11, v14
    v_cos_f32 v196, v11
    v_sin_f32 v197, v11
    v_add_f32 v11, v11, v14
    v_cos_f32 v198, v11
    v_sin_f32 v199, v11
    v_add_f32 v14, 0x3c000000, v14
    v_mul_f32 v11, v10, v14
    v_cos_f32 v200, v11
    v_sin_f32 v201, v11
    v_add_f32 v11, v11, v14
    v_cos_f32 v202, v11
    v_sin_f32 v203, v11
    v_add_f32 v11, v11, v14
    v_cos_f32 v204, v11
    v_sin_f32 v205, v11
    v_add_f32 v11, v11, v14
    v_cos_f32 v206, v11
    v_sin_f32 v207, v11
    s_waitcnt vmcnt(7)
    v_lshlrev_b32 v224, 16, v208
    v_lshlrev_b32 v228, 16, v210
    v_and_b32 v225, s72, v208
    v_and_b32 v229, s72, v210
    v_lshlrev_b32 v226, 16, v209
    v_lshlrev_b32 v230, 16, v211
    v_and_b32 v227, s72, v209
    v_and_b32 v231, s72, v211
    v_mul_f32 v232, v124, v228
    v_mul_f32 v124, v124, v224
    v_mul_f32 v233, v125, v229
    v_mul_f32 v125, v125, v225
    v_mul_f32 v234, v126, v230
    v_mul_f32 v126, v126, v226
    v_mul_f32 v235, v127, v231
    v_mul_f32 v127, v127, v227
    v_fmac_f32 v124, v120, v228
    v_fma_f32 v120, v120, v224, -v232
    v_fmac_f32 v125, v121, v229
    v_fma_f32 v121, v121, v225, -v233
    v_fmac_f32 v126, v122, v230
    v_fma_f32 v122, v122, v226, -v234
    v_fmac_f32 v127, v123, v231
    v_fma_f32 v123, v123, v227, -v235
    v_cvt_pk_bf16_f32 v152, v120, v121
    v_cvt_pk_bf16_f32 v156, v124, v125
    v_cvt_pk_bf16_f32 v153, v122, v123
    v_cvt_pk_bf16_f32 v157, v126, v127
    s_waitcnt vmcnt(6)
    v_lshlrev_b32 v224, 16, v212
    v_lshlrev_b32 v228, 16, v214
    v_and_b32 v225, s72, v212
    v_and_b32 v229, s72, v214
    v_lshlrev_b32 v226, 16, v213
    v_lshlrev_b32 v230, 16, v215
    v_and_b32 v227, s72, v213
    v_and_b32 v231, s72, v215
    v_mul_f32 v232, v132, v228
    v_mul_f32 v132, v132, v224
    v_mul_f32 v233, v133, v229
    v_mul_f32 v133, v133, v225
    v_mul_f32 v234, v134, v230
    v_mul_f32 v134, v134, v226
    v_mul_f32 v235, v135, v231
    v_mul_f32 v135, v135, v227
    v_fmac_f32 v132, v128, v228
    v_fma_f32 v128, v128, v224, -v232
    v_fmac_f32 v133, v129, v229
    v_fma_f32 v129, v129, v225, -v233
    v_fmac_f32 v134, v130, v230
    v_fma_f32 v130, v130, v226, -v234
    v_fmac_f32 v135, v131, v231
    v_fma_f32 v131, v131, v227, -v235
    v_cvt_pk_bf16_f32 v154, v128, v129
    v_cvt_pk_bf16_f32 v158, v132, v133
    v_cvt_pk_bf16_f32 v155, v130, v131
    v_cvt_pk_bf16_f32 v159, v134, v135
    s_waitcnt vmcnt(5)
    v_lshlrev_b32 v224, 16, v216
    v_lshlrev_b32 v228, 16, v218
    v_and_b32 v225, s72, v216
    v_and_b32 v229, s72, v218
    v_lshlrev_b32 v226, 16, v217
    v_lshlrev_b32 v230, 16, v219
    v_and_b32 v227, s72, v217
    v_and_b32 v231, s72, v219
    v_mul_f32 v232, v140, v228
    v_mul_f32 v140, v140, v224
    v_mul_f32 v233, v141, v229
    v_mul_f32 v141, v141, v225
    v_mul_f32 v234, v142, v230
    v_mul_f32 v142, v142, v226
    v_mul_f32 v235, v143, v231
    v_mul_f32 v143, v143, v227
    v_fmac_f32 v140, v136, v228
    v_fma_f32 v136, v136, v224, -v232
    v_fmac_f32 v141, v137, v229
    v_fma_f32 v137, v137, v225, -v233
    v_fmac_f32 v142, v138, v230
    v_fma_f32 v138, v138, v226, -v234
    v_fmac_f32 v143, v139, v231
    v_fma_f32 v139, v139, v227, -v235
    v_cvt_pk_bf16_f32 v164, v136, v137
    v_cvt_pk_bf16_f32 v168, v140, v141
    v_cvt_pk_bf16_f32 v165, v138, v139
    v_cvt_pk_bf16_f32 v169, v142, v143
    s_waitcnt vmcnt(4)
    v_lshlrev_b32 v224, 16, v220
    v_lshlrev_b32 v228, 16, v222
    v_and_b32 v225, s72, v220
    v_and_b32 v229, s72, v222
    v_lshlrev_b32 v226, 16, v221
    v_lshlrev_b32 v230, 16, v223
    v_and_b32 v227, s72, v221
    v_and_b32 v231, s72, v223
    v_mul_f32 v232, v148, v228
    v_mul_f32 v148, v148, v224
    v_mul_f32 v233, v149, v229
    v_mul_f32 v149, v149, v225
    v_mul_f32 v234, v150, v230
    v_mul_f32 v150, v150, v226
    v_mul_f32 v235, v151, v231
    v_mul_f32 v151, v151, v227
    v_fmac_f32 v148, v144, v228
    v_fma_f32 v144, v144, v224, -v232
    v_fmac_f32 v149, v145, v229
    v_fma_f32 v145, v145, v225, -v233
    v_fmac_f32 v150, v146, v230
    v_fma_f32 v146, v146, v226, -v234
    v_fmac_f32 v151, v147, v231
    v_fma_f32 v147, v147, v227, -v235
    v_cvt_pk_bf16_f32 v166, v144, v145
    v_cvt_pk_bf16_f32 v170, v148, v149
    v_cvt_pk_bf16_f32 v167, v146, v147
    v_cvt_pk_bf16_f32 v171, v150, v151
    v_xor_b32 v160, s71, v156
    v_xor_b32 v161, s71, v157
    v_xor_b32 v162, s71, v158
    v_xor_b32 v163, s71, v159
    v_xor_b32 v172, s71, v168
    v_xor_b32 v173, s71, v169
    v_xor_b32 v174, s71, v170
    v_xor_b32 v175, s71, v171
    v_mfma_f32_16x16x32_bf16 v[120:123], v[152:155], v[16:19], 0
    v_mfma_f32_16x16x32_bf16 v[124:127], v[156:159], v[16:19], 0
    v_mfma_f32_16x16x32_bf16 v[120:123], v[160:163], v[24:27], v[120:123]
    v_mfma_f32_16x16x32_bf16 v[124:127], v[152:155], v[24:27], v[124:127]
    v_mfma_f32_16x16x32_bf16 v[128:131], v[152:155], v[20:23], 0
    v_mfma_f32_16x16x32_bf16 v[132:135], v[156:159], v[20:23], 0
    v_mfma_f32_16x16x32_bf16 v[128:131], v[160:163], v[28:31], v[128:131]
    v_mfma_f32_16x16x32_bf16 v[132:135], v[152:155], v[28:31], v[132:135]
    s_waitcnt vmcnt(3)
    v_mfma_f32_16x16x32_bf16 v[136:139], v[164:167], v[48:51], 0
    v_mfma_f32_16x16x32_bf16 v[140:143], v[168:171], v[48:51], 0
    s_waitcnt vmcnt(1)
    v_mfma_f32_16x16x32_bf16 v[136:139], v[172:175], v[56:59], v[136:139]
    v_mfma_f32_16x16x32_bf16 v[140:143], v[164:167], v[56:59], v[140:143]
    v_mfma_f32_16x16x32_bf16 v[144:147], v[164:167], v[52:55], 0
    v_mfma_f32_16x16x32_bf16 v[148:151], v[168:171], v[52:55], 0
    s_waitcnt vmcnt(0)
    v_mfma_f32_16x16x32_bf16 v[144:147], v[172:175], v[60:63], v[144:147]
    v_mfma_f32_16x16x32_bf16 v[148:151], v[164:167], v[60:63], v[148:151]
    s_nop 1
    v_mul_f32 v224, s75, v136
    v_mul_f32 v225, s75, v137
    v_mul_f32 v226, s75, v138
    v_mul_f32 v227, s75, v139
    v_sub_f32 v136, v120, v224
    v_add_f32 v120, v120, v224
    v_sub_f32 v137, v121, v225
    v_add_f32 v121, v121, v225
    v_sub_f32 v138, v122, v226
    v_add_f32 v122, v122, v226
    v_sub_f32 v139, v123, v227
    v_add_f32 v123, v123, v227
    v_mul_f32 v224, s75, v140
    v_mul_f32 v225, s75, v141
    v_mul_f32 v226, s75, v142
    v_mul_f32 v227, s75, v143
    v_sub_f32 v140, v124, v224
    v_add_f32 v124, v124, v224
    v_sub_f32 v141, v125, v225
    v_add_f32 v125, v125, v225
    v_sub_f32 v142, v126, v226
    v_add_f32 v126, v126, v226
    v_sub_f32 v143, v127, v227
    v_add_f32 v127, v127, v227
    v_mul_f32 v224, s75, v144
    v_mul_f32 v225, s75, v145
    v_mul_f32 v226, s75, v146
    v_mul_f32 v227, s75, v147
    v_sub_f32 v144, v128, v224
    v_add_f32 v128, v128, v224
    v_sub_f32 v145, v129, v225
    v_add_f32 v129, v129, v225
    v_sub_f32 v146, v130, v226
    v_add_f32 v130, v130, v226
    v_sub_f32 v147, v131, v227
    v_add_f32 v131, v131, v227
    v_mul_f32 v224, s75, v148
    v_mul_f32 v225, s75, v149
    v_mul_f32 v226, s75, v150
    v_mul_f32 v227, s75, v151
    v_sub_f32 v148, v132, v224
    v_add_f32 v132, v132, v224
    v_sub_f32 v149, v133, v225
    v_add_f32 v133, v133, v225
    v_sub_f32 v150, v134, v226
    v_add_f32 v134, v134, v226
    v_sub_f32 v151, v135, v227
    v_add_f32 v135, v135, v227
    v_mul_f32 v224, v140, v193
    v_mul_f32 v140, v140, v192
    v_mul_f32 v225, v141, v195
    v_mul_f32 v141, v141, v194
    v_mul_f32 v226, v142, v197
    v_mul_f32 v142, v142, v196
    v_mul_f32 v227, v143, v199
    v_mul_f32 v143, v143, v198
    v_fmac_f32 v140, v136, v193
    v_fma_f32 v136, v136, v192, -v224
    v_fmac_f32 v141, v137, v195
    v_fma_f32 v137, v137, v194, -v225
    v_fmac_f32 v142, v138, v197
    v_fma_f32 v138, v138, v196, -v226
    v_fmac_f32 v143, v139, v199
    v_fma_f32 v139, v139, v198, -v227
    v_cvt_pk_bf16_f32 v160, v136, v137
    v_cvt_pk_bf16_f32 v161, v138, v139
    ds_write_b64 v9, v[160:161] offset:0
    v_cvt_pk_bf16_f32 v162, v140, v141
    v_cvt_pk_bf16_f32 v163, v142, v143
    ds_write_b64 v9, v[162:163] offset:1024
    v_mul_f32 v224, v148, v201
    v_mul_f32 v148, v148, v200
    v_mul_f32 v225, v149, v203
    v_mul_f32 v149, v149, v202
    v_mul_f32 v226, v150, v205
    v_mul_f32 v150, v150, v204
    v_mul_f32 v227, v151, v207
    v_mul_f32 v151, v151, v206
    v_fmac_f32 v148, v144, v201
    v_fma_f32 v144, v144, v200, -v224
    v_fmac_f32 v149, v145, v203
    v_fma_f32 v145, v145, v202, -v225
    v_fmac_f32 v150, v146, v205
    v_fma_f32 v146, v146, v204, -v226
    v_fmac_f32 v151, v147, v207
    v_fma_f32 v147, v147, v206, -v227
    v_cvt_pk_bf16_f32 v164, v144, v145
    v_cvt_pk_bf16_f32 v165, v146, v147
    ds_write_b64 v9, v[164:165] offset:2048
    v_cvt_pk_bf16_f32 v166, v148, v149
    v_cvt_pk_bf16_f32 v167, v150, v151
    ds_write_b64 v9, v[166:167] offset:3072
    v_mov_b32 v11, 1
    ds_write_b32 v15, v11
    v_mul_f32 v224, v124, v177
    v_mul_f32 v124, v124, v176
    v_mul_f32 v225, v125, v179
    v_mul_f32 v125, v125, v178
    v_mul_f32 v226, v126, v181
    v_mul_f32 v126, v126, v180
    v_mul_f32 v227, v127, v183
    v_mul_f32 v127, v127, v182
    v_fmac_f32 v124, v120, v177
    v_fma_f32 v120, v120, v176, -v224
    v_fmac_f32 v125, v121, v179
    v_fma_f32 v121, v121, v178, -v225
    v_fmac_f32 v126, v122, v181
    v_fma_f32 v122, v122, v180, -v226
    v_fmac_f32 v127, v123, v183
    v_fma_f32 v123, v123, v182, -v227
    v_cvt_pk_bf16_f32 v152, v120, v121
    v_cvt_pk_bf16_f32 v153, v122, v123
    ds_write_b64 v8, v[152:153] offset:0
    v_cvt_pk_bf16_f32 v154, v124, v125
    v_cvt_pk_bf16_f32 v155, v126, v127
    ds_write_b64 v8, v[154:155] offset:1024
    v_mul_f32 v224, v132, v185
    v_mul_f32 v132, v132, v184
    v_mul_f32 v225, v133, v187
    v_mul_f32 v133, v133, v186
    v_mul_f32 v226, v134, v189
    v_mul_f32 v134, v134, v188
    v_mul_f32 v227, v135, v191
    v_mul_f32 v135, v135, v190
    v_fmac_f32 v132, v128, v185
    v_fma_f32 v128, v128, v184, -v224
    v_fmac_f32 v133, v129, v187
    v_fma_f32 v129, v129, v186, -v225
    v_fmac_f32 v134, v130, v189
    v_fma_f32 v130, v130, v188, -v226
    v_fmac_f32 v135, v131, v191
    v_fma_f32 v131, v131, v190, -v227
    v_cvt_pk_bf16_f32 v156, v128, v129
    v_cvt_pk_bf16_f32 v157, v130, v131
    ds_write_b64 v8, v[156:157] offset:2048
    v_cvt_pk_bf16_f32 v158, v132, v133
    v_cvt_pk_bf16_f32 v159, v134, v135
    ds_write_b64 v8, v[158:159] offset:3072
SPF10_k2_kernel:
    ds_read_b32 v11, v7 offset:0
    s_waitcnt lgkmcnt(0)
    v_readfirstlane_b32 s52, v11
    s_nop 2
    s_cmp_lt_u32 s52, 1
    s_cbranch_scc1 SPF10_k2_kernel
    ds_read_b128 v[72:75], v12 offset:0
    ds_read_b128 v[76:79], v12 offset:1024
    ds_read_b128 v[84:87], v12 offset:2048
    ds_read_b128 v[88:91], v12 offset:3072
    s_waitcnt lgkmcnt(2)
    v_xor_b32 v80, s71, v76
    v_xor_b32 v81, s71, v77
    v_xor_b32 v82, s71, v78
    v_xor_b32 v83, s71, v79
    v_mfma_f32_16x16x32_bf16 v[120:123], v[16:19], v[72:75], 0
    v_mfma_f32_16x16x32_bf16 v[124:127], v[16:19], v[76:79], 0
    v_mfma_f32_16x16x32_bf16 v[120:123], v[24:27], v[80:83], v[120:123]
    v_mfma_f32_16x16x32_bf16 v[124:127], v[24:27], v[72:75], v[124:127]
    v_mfma_f32_16x16x32_bf16 v[128:131], v[20:23], v[72:75], 0
    v_mfma_f32_16x16x32_bf16 v[132:135], v[20:23], v[76:79], 0
    v_mfma_f32_16x16x32_bf16 v[128:131], v[28:31], v[80:83], v[128:131]
    v_mfma_f32_16x16x32_bf16 v[132:135], v[28:31], v[72:75], v[132:135]
    s_waitcnt lgkmcnt(0)
    v_xor_b32 v92, s71, v88
    v_xor_b32 v93, s71, v89
    v_xor_b32 v94, s71, v90
    v_xor_b32 v95, s71, v91
    v_mfma_f32_16x16x32_bf16 v[136:139], v[16:19], v[84:87], 0
    v_mfma_f32_16x16x32_bf16 v[140:143], v[16:19], v[88:91], 0
    v_mfma_f32_16x16x32_bf16 v[136:139], v[24:27], v[92:95], v[136:139]
    v_mfma_f32_16x16x32_bf16 v[140:143], v[24:27], v[84:87], v[140:143]
    v_mfma_f32_16x16x32_bf16 v[144:147], v[20:23], v[84:87], 0
    v_mfma_f32_16x16x32_bf16 v[148:151], v[20:23], v[88:91], 0
    v_mfma_f32_16x16x32_bf16 v[144:147], v[28:31], v[92:95], v[144:147]
    v_mfma_f32_16x16x32_bf16 v[148:151], v[28:31], v[84:87], v[148:151]
    v_cvt_pk_bf16_f32 v152, v120, v121
    v_cvt_pk_bf16_f32 v153, v122, v123
    v_cvt_pk_bf16_f32 v154, v124, v125
    v_cvt_pk_bf16_f32 v155, v126, v127
    buffer_store_dwordx4 v[152:155], v4, s[24:27], s62 offen offset:0 sc1
    v_cvt_pk_bf16_f32 v156, v128, v129
    v_cvt_pk_bf16_f32 v157, v130, v131
    v_cvt_pk_bf16_f32 v158, v132, v133
    v_cvt_pk_bf16_f32 v159, v134, v135
    buffer_store_dwordx4 v[156:159], v4, s[24:27], s62 offen offset:256 sc1
    v_cvt_pk_bf16_f32 v160, v136, v137
    v_cvt_pk_bf16_f32 v161, v138, v139
    v_cvt_pk_bf16_f32 v162, v140, v141
    v_cvt_pk_bf16_f32 v163, v142, v143
    buffer_store_dwordx4 v[160:163], v4, s[24:27], s62 offen offset:2048 sc1
    v_cvt_pk_bf16_f32 v164, v144, v145
    v_cvt_pk_bf16_f32 v165, v146, v147
    v_cvt_pk_bf16_f32 v166, v148, v149
    v_cvt_pk_bf16_f32 v167, v150, v151
    buffer_store_dwordx4 v[164:167], v4, s[24:27], s62 offen offset:2304 sc1
END_k2_kernel:
    s_endpgm
.globl k3_kernel
.p2align 8
.type k3_kernel,@function
k3_kernel:
    s_cmpk_ge_u32 s2, 256
    s_cbranch_scc1 END_k3_kernel
    s_load_dwordx2 s[24:25], s[0:1], 64
    s_load_dwordx2 s[36:37], s[0:1], 0
    s_load_dwordx2 s[40:41], s[0:1], 48
    v_lshrrev_b32 v4, 6, v0
    v_and_b32 v1, 63, v0
    v_readfirstlane_b32 s3, v4
    s_mov_b32 s26, 0x2000000
    s_mov_b32 s27, 0x20000
    s_and_b32 s56, s2, 7
    s_lshr_b32 s59, s2, 5
    s_lshl3_add_u32 s58, s56, s59
    s_bfe_u32 s60, s2, 0x20003
    v_lshrrev_b32 v26, 3, v1
    v_lshlrev_b32 v6, 13, v26
    v_and_b32 v26, 4, v26
    v_and_b32 v27, 7, v0
    v_xor_b32 v26, v27, v26
    v_lshl_add_u32 v6, v26, 4, v6
    s_lshl_b32 s62, s58, 7
    s_lshl_b32 s63, s3, 18
    s_add_u32 s62, s62, s63
    s_add_u32 s62, s62, 12582912
    s_lshl_b32 s75, s3, 12
    v_add_u32 v7, 64512, v6
    v_add_u32 v8, 129024, v6
    v_add_u32 v9, 193536, v6
    s_mov_b32 m0, s75
    s_waitcnt lgkmcnt(0)
    buffer_load_dwordx4 v6, s[24:27], s62 offen offset:0 lds
    buffer_load_dwordx4 v7, s[24:27], s62 offen offset:1024 lds
    buffer_load_dwordx4 v8, s[24:27], s62 offen offset:2048 lds
    buffer_load_dwordx4 v9, s[24:27], s62 offen offset:3072 lds
    v_lshrrev_b32 v2, 4, v1
    v_and_b32 v3, 15, v0
    s_lshl3_add_u32 s61, s60, s3
    v_lshl_add_u32 v10, s61, 4, v3
    v_cvt_f32_u32 v10, v10
    v_mul_f32 v10, 0xbb000000, v10
    v_mul_f32 v11, 0x41500000, v10
    v_mul_f32 v13, 0x41800000, v10
    v_lshl_add_u32 v12, v2, 2, 1
    v_cos_f32 v13, v13
    v_cvt_f32_u32 v12, v12
    v_mul_f32 v12, v12, v10
    v_add_f32 v13, v13, v13
    v_lshlrev_b32 v5, 4, v1
    s_lshr_b32 s65, s58, 1
    s_lshl2_add_u32 s65, s65, s60
    s_lshl3_add_u32 s65, s65, s3
    s_and_b32 s64, s58, 1
    s_lshl1_add_u32 s65, s65, s64
    s_lshl_b32 s65, s65, 10
    s_add_u32 s65, s65, 20971520
    s_mov_b32 s66, 0x200000
    v_cos_f32 v164, v12
    v_sin_f32 v165, v12
    v_add_f32 v12, v12, v10
    v_cvt_pk_bf16_f32 v32, v164, v165
    v_cos_f32 v166, v12
    v_sin_f32 v167, v12
    v_add_f32 v12, v12, v10
    v_cvt_pk_bf16_f32 v33, v166, v167
    v_cos_f32 v168, v12
    v_sin_f32 v169, v12
    v_add_f32 v12, v12, v10
    v_cvt_pk_bf16_f32 v34, v168, v169
    v_cos_f32 v170, v12
    v_sin_f32 v171, v12
    v_add_f32 v12, v12, v11
    v_cvt_pk_bf16_f32 v35, v170, v171
    v_cos_f32 v172, v12
    v_sin_f32 v173, v12
    v_add_f32 v12, v12, v10
    v_cvt_pk_bf16_f32 v36, v172, v173
    v_cos_f32 v174, v12
    v_sin_f32 v175, v12
    v_add_f32 v12, v12, v10
    v_cvt_pk_bf16_f32 v37, v174, v175
    v_cos_f32 v176, v12
    v_sin_f32 v177, v12
    v_add_f32 v12, v12, v10
    v_cvt_pk_bf16_f32 v38, v176, v177
    v_cos_f32 v178, v12
    v_sin_f32 v179, v12
    s_nop 0
    v_cvt_pk_bf16_f32 v39, v178, v179
    buffer_load_dwordx4 v[140:143], v5, s[24:27], s65 offen
    s_add_u32 s65, s65, s66
    buffer_load_dwordx4 v[144:147], v5, s[24:27], s65 offen
    s_add_u32 s65, s65, s66
    buffer_load_dwordx4 v[148:151], v5, s[24:27], s65 offen
    s_add_u32 s65, s65, s66
    buffer_load_dwordx4 v[152:155], v5, s[24:27], s65 offen
    v_fma_f32 v164, v13, v172, -v164
    v_fma_f32 v165, v13, v173, -v165
    v_fma_f32 v166, v13, v174, -v166
    v_fma_f32 v167, v13, v175, -v167
    v_fma_f32 v168, v13, v176, -v168
    v_fma_f32 v169, v13, v177, -v169
    v_fma_f32 v170, v13, v178, -v170
    v_fma_f32 v171, v13, v179, -v171
    v_cvt_pk_bf16_f32 v40, v164, v165
    v_cvt_pk_bf16_f32 v41, v166, v167
    v_cvt_pk_bf16_f32 v42, v168, v169
    v_cvt_pk_bf16_f32 v43, v170, v171
    v_fma_f32 v172, v13, v164, -v172
    v_fma_f32 v173, v13, v165, -v173
    v_fma_f32 v174, v13, v166, -v174
    v_fma_f32 v175, v13, v167, -v175
    v_fma_f32 v176, v13, v168, -v176
    v_fma_f32 v177, v13, v169, -v177
    v_fma_f32 v178, v13, v170, -v178
    v_fma_f32 v179, v13, v171, -v179
    v_cvt_pk_bf16_f32 v44, v172, v173
    v_cvt_pk_bf16_f32 v45, v174, v175
    v_cvt_pk_bf16_f32 v46, v176, v177
    v_cvt_pk_bf16_f32 v47, v178, v179
    v_fma_f32 v164, v13, v172, -v164
    v_fma_f32 v165, v13, v173, -v165
    v_fma_f32 v166, v13, v174, -v166
    v_fma_f32 v167, v13, v175, -v167
    v_fma_f32 v168, v13, v176, -v168
    v_fma_f32 v169, v13, v177, -v169
    v_fma_f32 v170, v13, v178, -v170
    v_fma_f32 v171, v13, v179, -v171
    v_cvt_pk_bf16_f32 v48, v164, v165
    v_cvt_pk_bf16_f32 v49, v166, v167
    v_cvt_pk_bf16_f32 v50, v168, v169
    v_cvt_pk_bf16_f32 v51, v170, v171
    v_fma_f32 v172, v13, v164, -v172
    v_fma_f32 v173, v13, v165, -v173
    v_fma_f32 v174, v13, v166, -v174
    v_fma_f32 v175, v13, v167, -v175
    v_fma_f32 v176, v13, v168, -v176
    v_fma_f32 v177, v13, v169, -v177
    v_fma_f32 v178, v13, v170, -v178
    v_fma_f32 v179, v13, v171, -v179
    v_cvt_pk_bf16_f32 v52, v172, v173
    v_cvt_pk_bf16_f32 v53, v174, v175
    v_cvt_pk_bf16_f32 v54, v176, v177
    v_cvt_pk_bf16_f32 v55, v178, v179
    v_fma_f32 v164, v13, v172, -v164
    v_fma_f32 v165, v13, v173, -v165
    v_fma_f32 v166, v13, v174, -v166
    v_fma_f32 v167, v13, v175, -v167
    v_fma_f32 v168, v13, v176, -v168
    v_fma_f32 v169, v13, v177, -v169
    v_fma_f32 v170, v13, v178, -v170
    v_fma_f32 v171, v13, v179, -v171
    v_cvt_pk_bf16_f32 v56, v164, v165
    v_cvt_pk_bf16_f32 v57, v166, v167
    v_cvt_pk_bf16_f32 v58, v168, v169
    v_cvt_pk_bf16_f32 v59, v170, v171
    v_fma_f32 v172, v13, v164, -v172
    v_fma_f32 v173, v13, v165, -v173
    v_fma_f32 v174, v13, v166, -v174
    v_fma_f32 v175, v13, v167, -v175
    v_fma_f32 v176, v13, v168, -v176
    v_fma_f32 v177, v13, v169, -v177
    v_fma_f32 v178, v13, v170, -v178
    v_fma_f32 v179, v13, v171, -v179
    v_cvt_pk_bf16_f32 v60, v172, v173
    v_cvt_pk_bf16_f32 v61, v174, v175
    v_cvt_pk_bf16_f32 v62, v176, v177
    v_cvt_pk_bf16_f32 v63, v178, v179
    v_lshlrev_b32 v12, 16, v2
    v_lshl_or_b32 v12, v3, 4, v12
    s_bfe_u32 s63, s58, 0x20002
    s_bfe_u32 s64, s58, 0x10001
    s_lshl2_add_u32 s63, s64, s63
    s_lshr_b32 s64, s58, 4
    s_lshl4_add_u32 s63, s63, s64
    s_and_b32 s64, s58, 1
    s_lshl1_add_u32 s63, s63, s64
    s_lshl3_add_u32 s63, s63, s3
    s_lshl2_add_u32 s63, s63, s60
    s_lshl_b32 s63, s63, 8
    s_mov_b32 s38, 0x200000
    s_mov_b32 s39, 0x20000
    s_mov_b32 s42, 0x200000
    s_mov_b32 s43, 0x20000
    buffer_load_dwordx4 v[120:123], v12, s[36:39], s63 offen
    v_bfe_u32 v24, v0, 3, 1
    v_lshl_add_u32 v24, v2, 2, v24
    v_lshlrev_b32 v24, 7, v24
    v_and_b32 v25, 3, v0
    v_lshl_add_u32 v24, v25, 4, v24
    v_and_b32 v25, 4, v0
    v_lshl_add_u32 v24, v25, 1, v24
    v_and_b32 v25, 16, v0
    v_lshl_add_u32 v28, v25, 2, v24
    v_xor_b32 v29, 64, v28
    v_mul_u32_u24 v14, 272, v3
    v_lshl_add_u32 v14, v2, 3, v14
    s_lshl_b32 s64, s3, 5
    s_add_u32 s64, s64, 32768
    v_add_u32 v14, s64, v14
    v_mul_u32_u24 v15, 272, v2
    v_lshl_add_u32 v15, v3, 4, v15
    s_mul_i32 s64, s3, 1088
    s_add_u32 s64, s64, 32768
    v_add_u32 v15, s64, v15
    s_mov_b32 s66, 0xffff0000
    s_mov_b32 s67, 0xbf317218
    v_fma_f32 v164, v13, v172, -v164
    v_fma_f32 v165, v13, v173, -v165
    v_fma_f32 v166, v13, v174, -v166
    v_fma_f32 v167, v13, v175, -v167
    v_fma_f32 v168, v13, v176, -v168
    v_fma_f32 v169, v13, v177, -v169
    v_fma_f32 v170, v13, v178, -v170
    v_fma_f32 v171, v13, v179, -v171
    v_cvt_pk_bf16_f32 v64, v164, v165
    v_cvt_pk_bf16_f32 v65, v166, v167
    v_cvt_pk_bf16_f32 v66, v168, v169
    v_cvt_pk_bf16_f32 v67, v170, v171
    v_fma_f32 v172, v13, v164, -v172
    v_fma_f32 v173, v13, v165, -v173
    v_fma_f32 v174, v13, v166, -v174
    v_fma_f32 v175, v13, v167, -v175
    v_fma_f32 v176, v13, v168, -v176
    v_fma_f32 v177, v13, v169, -v177
    v_fma_f32 v178, v13, v170, -v178
    v_fma_f32 v179, v13, v171, -v179
    v_cvt_pk_bf16_f32 v68, v172, v173
    v_cvt_pk_bf16_f32 v69, v174, v175
    v_cvt_pk_bf16_f32 v70, v176, v177
    v_cvt_pk_bf16_f32 v71, v178, v179
    v_fma_f32 v164, v13, v172, -v164
    v_fma_f32 v165, v13, v173, -v165
    v_fma_f32 v166, v13, v174, -v166
    v_fma_f32 v167, v13, v175, -v167
    v_fma_f32 v168, v13, v176, -v168
    v_fma_f32 v169, v13, v177, -v169
    v_fma_f32 v170, v13, v178, -v170
    v_fma_f32 v171, v13, v179, -v171
    v_cvt_pk_bf16_f32 v72, v164, v165
    v_cvt_pk_bf16_f32 v73, v166, v167
    v_cvt_pk_bf16_f32 v74, v168, v169
    v_cvt_pk_bf16_f32 v75, v170, v171
    v_fma_f32 v172, v13, v164, -v172
    v_fma_f32 v173, v13, v165, -v173
    v_fma_f32 v174, v13, v166, -v174
    v_fma_f32 v175, v13, v167, -v175
    v_fma_f32 v176, v13, v168, -v176
    v_fma_f32 v177, v13, v169, -v177
    v_fma_f32 v178, v13, v170, -v178
    v_fma_f32 v179, v13, v171, -v179
    v_cvt_pk_bf16_f32 v76, v172, v173
    v_cvt_pk_bf16_f32 v77, v174, v175
    v_cvt_pk_bf16_f32 v78, v176, v177
    v_cvt_pk_bf16_f32 v79, v178, v179
    v_fma_f32 v164, v13, v172, -v164
    v_fma_f32 v165, v13, v173, -v165
    v_fma_f32 v166, v13, v174, -v166
    v_fma_f32 v167, v13, v175, -v167
    v_fma_f32 v168, v13, v176, -v168
    v_fma_f32 v169, v13, v177, -v169
    v_fma_f32 v170, v13, v178, -v170
    v_fma_f32 v171, v13, v179, -v171
    v_cvt_pk_bf16_f32 v80, v164, v165
    v_cvt_pk_bf16_f32 v81, v166, v167
    v_cvt_pk_bf16_f32 v82, v168, v169
    v_cvt_pk_bf16_f32 v83, v170, v171
    v_fma_f32 v172, v13, v164, -v172
    v_fma_f32 v173, v13, v165, -v173
    v_fma_f32 v174, v13, v166, -v174
    v_fma_f32 v175, v13, v167, -v175
    v_fma_f32 v176, v13, v168, -v176
    v_fma_f32 v177, v13, v169, -v177
    v_fma_f32 v178, v13, v170, -v178
    v_fma_f32 v179, v13, v171, -v179
    v_cvt_pk_bf16_f32 v84, v172, v173
    v_cvt_pk_bf16_f32 v85, v174, v175
    v_cvt_pk_bf16_f32 v86, v176, v177
    v_cvt_pk_bf16_f32 v87, v178, v179
    v_fma_f32 v164, v13, v172, -v164
    v_fma_f32 v165, v13, v173, -v165
    v_fma_f32 v166, v13, v174, -v166
    v_fma_f32 v167, v13, v175, -v167
    v_fma_f32 v168, v13, v176, -v168
    v_fma_f32 v169, v13, v177, -v169
    v_fma_f32 v170, v13, v178, -v170
    v_fma_f32 v171, v13, v179, -v171
    v_cvt_pk_bf16_f32 v88, v164, v165
    v_cvt_pk_bf16_f32 v89, v166, v167
    v_cvt_pk_bf16_f32 v90, v168, v169
    v_cvt_pk_bf16_f32 v91, v170, v171
    v_fma_f32 v172, v13, v164, -v172
    v_fma_f32 v173, v13, v165, -v173
    v_fma_f32 v174, v13, v166, -v174
    v_fma_f32 v175, v13, v167, -v175
    v_fma_f32 v176, v13, v168, -v176
    v_fma_f32 v177, v13, v169, -v177
    v_fma_f32 v178, v13, v170, -v178
    v_fma_f32 v179, v13, v171, -v179
    v_cvt_pk_bf16_f32 v92, v172, v173
    v_cvt_pk_bf16_f32 v93, v174, v175
    v_cvt_pk_bf16_f32 v94, v176, v177
    v_cvt_pk_bf16_f32 v95, v178, v179
    s_waitcnt vmcnt(5)
    s_barrier
    ds_read_b64_tr_b16 v[104:105], v28 offset:0
    ds_read_b64_tr_b16 v[106:107], v28 offset:256
    ds_read_b64_tr_b16 v[108:109], v29 offset:0
    ds_read_b64_tr_b16 v[110:111], v29 offset:256
    ds_read_b64_tr_b16 v[112:113], v28 offset:2048
    ds_read_b64_tr_b16 v[114:115], v28 offset:2304
    ds_read_b64_tr_b16 v[116:117], v29 offset:2048
    ds_read_b64_tr_b16 v[118:119], v29 offset:2304
    s_waitcnt lgkmcnt(6)
    v_mfma_f32_16x16x32_bf16 v[96:99], v[32:35], v[104:107], 0
    s_waitcnt lgkmcnt(4)
    v_mfma_f32_16x16x32_bf16 v[100:103], v[32:35], v[108:111], 0
    ds_read_b64_tr_b16 v[104:105], v28 offset:4096
    ds_read_b64_tr_b16 v[106:107], v28 offset:4352
    ds_read_b64_tr_b16 v[108:109], v29 offset:4096
    ds_read_b64_tr_b16 v[110:111], v29 offset:4352
    s_waitcnt lgkmcnt(6)
    v_mfma_f32_16x16x32_bf16 v[96:99], v[36:39], v[112:115], v[96:99]
    s_waitcnt lgkmcnt(4)
    v_mfma_f32_16x16x32_bf16 v[100:103], v[36:39], v[116:119], v[100:103]
    ds_read_b64_tr_b16 v[112:113], v28 offset:6144
    ds_read_b64_tr_b16 v[114:115], v28 offset:6400
    ds_read_b64_tr_b16 v[116:117], v29 offset:6144
    ds_read_b64_tr_b16 v[118:119], v29 offset:6400
    s_waitcnt lgkmcnt(6)
    v_mfma_f32_16x16x32_bf16 v[96:99], v[40:43], v[104:107], v[96:99]
    s_waitcnt lgkmcnt(4)
    v_mfma_f32_16x16x32_bf16 v[100:103], v[40:43], v[108:111], v[100:103]
    ds_read_b64_tr_b16 v[104:105], v28 offset:8192
    ds_read_b64_tr_b16 v[106:107], v28 offset:8448
    ds_read_b64_tr_b16 v[108:109], v29 offset:8192
    ds_read_b64_tr_b16 v[110:111], v29 offset:8448
    s_waitcnt lgkmcnt(6)
    v_mfma_f32_16x16x32_bf16 v[96:99], v[44:47], v[112:115], v[96:99]
    s_waitcnt lgkmcnt(4)
    v_mfma_f32_16x16x32_bf16 v[100:103], v[44:47], v[116:119], v[100:103]
    ds_read_b64_tr_b16 v[112:113], v28 offset:10240
    ds_read_b64_tr_b16 v[114:115], v28 offset:10496
    ds_read_b64_tr_b16 v[116:117], v29 offset:10240
    ds_read_b64_tr_b16 v[118:119], v29 offset:10496
    s_waitcnt lgkmcnt(6)
    v_mfma_f32_16x16x32_bf16 v[96:99], v[48:51], v[104:107], v[96:99]
    s_waitcnt vmcnt(4)
    v_lshlrev_b32 v156, 16, v140
    v_and_b32 v157, s66, v140
    s_waitcnt vmcnt(3)
    v_lshlrev_b32 v126, 16, v144
    v_and_b32 v127, s66, v144
    s_waitcnt lgkmcnt(4)
    v_mfma_f32_16x16x32_bf16 v[100:103], v[48:51], v[108:111], v[100:103]
    v_add_f32 v156, v156, v126
    v_add_f32 v157, v157, v127
    s_waitcnt vmcnt(2)
    v_lshlrev_b32 v124, 16, v148
    v_and_b32 v125, s66, v148
    ds_read_b64_tr_b16 v[104:105], v28 offset:12288
    ds_read_b64_tr_b16 v[106:107], v28 offset:12544
    ds_read_b64_tr_b16 v[108:109], v29 offset:12288
    ds_read_b64_tr_b16 v[110:111], v29 offset:12544
    s_waitcnt lgkmcnt(6)
    v_mfma_f32_16x16x32_bf16 v[96:99], v[52:55], v[112:115], v[96:99]
    v_add_f32 v156, v156, v124
    v_add_f32 v157, v157, v125
    s_waitcnt vmcnt(1)
    v_lshlrev_b32 v126, 16, v152
    v_and_b32 v127, s66, v152
    s_waitcnt lgkmcnt(4)
    v_mfma_f32_16x16x32_bf16 v[100:103], v[52:55], v[116:119], v[100:103]
    v_add_f32 v156, v156, v126
    v_add_f32 v157, v157, v127
    v_lshlrev_b32 v158, 16, v141
    v_and_b32 v159, s66, v141
    ds_read_b64_tr_b16 v[112:113], v28 offset:14336
    ds_read_b64_tr_b16 v[114:115], v28 offset:14592
    ds_read_b64_tr_b16 v[116:117], v29 offset:14336
    ds_read_b64_tr_b16 v[118:119], v29 offset:14592
    s_waitcnt lgkmcnt(6)
    v_mfma_f32_16x16x32_bf16 v[96:99], v[56:59], v[104:107], v[96:99]
    v_lshlrev_b32 v126, 16, v145
    v_and_b32 v127, s66, v145
    v_add_f32 v158, v158, v126
    v_add_f32 v159, v159, v127
    s_waitcnt lgkmcnt(4)
    v_mfma_f32_16x16x32_bf16 v[100:103], v[56:59], v[108:111], v[100:103]
    v_lshlrev_b32 v124, 16, v149
    v_and_b32 v125, s66, v149
    v_add_f32 v158, v158, v124
    v_add_f32 v159, v159, v125
    ds_read_b64_tr_b16 v[104:105], v28 offset:16384
    ds_read_b64_tr_b16 v[106:107], v28 offset:16640
    ds_read_b64_tr_b16 v[108:109], v29 offset:16384
    ds_read_b64_tr_b16 v[110:111], v29 offset:16640
    s_waitcnt lgkmcnt(6)
    v_mfma_f32_16x16x32_bf16 v[96:99], v[60:63], v[112:115], v[96:99]
    v_lshlrev_b32 v126, 16, v153
    v_and_b32 v127, s66, v153
    v_add_f32 v158, v158, v126
    v_add_f32 v159, v159, v127
    s_waitcnt lgkmcnt(4)
    v_mfma_f32_16x16x32_bf16 v[100:103], v[60:63], v[116:119], v[100:103]
    v_lshlrev_b32 v160, 16, v142
    v_and_b32 v161, s66, v142
    v_lshlrev_b32 v126, 16, v146
    v_and_b32 v127, s66, v146
    ds_read_b64_tr_b16 v[112:113], v28 offset:18432
    ds_read_b64_tr_b16 v[114:115], v28 offset:18688
    ds_read_b64_tr_b16 v[116:117], v29 offset:18432
    ds_read_b64_tr_b16 v[118:119], v29 offset:18688
    s_waitcnt lgkmcnt(6)
    v_mfma_f32_16x16x32_bf16 v[96:99], v[64:67], v[104:107], v[96:99]
    v_add_f32 v160, v160, v126
    v_add_f32 v161, v161, v127
    v_lshlrev_b32 v124, 16, v150
    v_and_b32 v125, s66, v150
    s_waitcnt lgkmcnt(4)
    v_mfma_f32_16x16x32_bf16 v[100:103], v[64:67], v[108:111], v[100:103]
    v_add_f32 v160, v160, v124
    v_add_f32 v161, v161, v125
    v_lshlrev_b32 v126, 16, v154
    v_and_b32 v127, s66, v154
    ds_read_b64_tr_b16 v[104:105], v28 offset:20480
    ds_read_b64_tr_b16 v[106:107], v28 offset:20736
    ds_read_b64_tr_b16 v[108:109], v29 offset:20480
    ds_read_b64_tr_b16 v[110:111], v29 offset:20736
    s_waitcnt lgkmcnt(6)
    v_mfma_f32_16x16x32_bf16 v[96:99], v[68:71], v[112:115], v[96:99]
    v_add_f32 v160, v160, v126
    v_add_f32 v161, v161, v127
    v_lshlrev_b32 v162, 16, v143
    v_and_b32 v163, s66, v143
    s_waitcnt lgkmcnt(4)
    v_mfma_f32_16x16x32_bf16 v[100:103], v[68:71], v[116:119], v[100:103]
    v_lshlrev_b32 v126, 16, v147
    v_and_b32 v127, s66, v147
    v_add_f32 v162, v162, v126
    v_add_f32 v163, v163, v127
    ds_read_b64_tr_b16 v[112:113], v28 offset:22528
    ds_read_b64_tr_b16 v[114:115], v28 offset:22784
    ds_read_b64_tr_b16 v[116:117], v29 offset:22528
    ds_read_b64_tr_b16 v[118:119], v29 offset:22784
    s_waitcnt lgkmcnt(6)
    v_mfma_f32_16x16x32_bf16 v[96:99], v[72:75], v[104:107], v[96:99]
    v_lshlrev_b32 v124, 16, v151
    v_and_b32 v125, s66, v151
    v_add_f32 v162, v162, v124
    v_add_f32 v163, v163, v125
    s_waitcnt lgkmcnt(4)
    v_mfma_f32_16x16x32_bf16 v[100:103], v[72:75], v[108:111], v[100:103]
    v_lshlrev_b32 v126, 16, v155
    v_and_b32 v127, s66, v155
    v_add_f32 v162, v162, v126
    v_add_f32 v163, v163, v127
    ds_read_b64_tr_b16 v[104:105], v28 offset:24576
    ds_read_b64_tr_b16 v[106:107], v28 offset:24832
    ds_read_b64_tr_b16 v[108:109], v29 offset:24576
    ds_read_b64_tr_b16 v[110:111], v29 offset:24832
    s_waitcnt lgkmcnt(6)
    v_mfma_f32_16x16x32_bf16 v[96:99], v[76:79], v[112:115], v[96:99]
    v_exp_f32 v124, v156
    v_exp_f32 v125, v157
    v_exp_f32 v126, v158
    v_exp_f32 v127, v159
    s_waitcnt lgkmcnt(4)
    v_mfma_f32_16x16x32_bf16 v[100:103], v[76:79], v[116:119], v[100:103]
    v_exp_f32 v128, v160
    v_exp_f32 v129, v161
    v_exp_f32 v130, v162
    v_exp_f32 v131, v163
    ds_read_b64_tr_b16 v[112:113], v28 offset:26624
    ds_read_b64_tr_b16 v[114:115], v28 offset:26880
    ds_read_b64_tr_b16 v[116:117], v29 offset:26624
    ds_read_b64_tr_b16 v[118:119], v29 offset:26880
    s_waitcnt lgkmcnt(6)
    v_mfma_f32_16x16x32_bf16 v[96:99], v[80:83], v[104:107], v[96:99]
    v_mul_f32 v156, s67, v156
    v_mul_f32 v157, s67, v157
    v_mul_f32 v158, s67, v158
    v_mul_f32 v159, s67, v159
    s_waitcnt lgkmcnt(4)
    v_mfma_f32_16x16x32_bf16 v[100:103], v[80:83], v[108:111], v[100:103]
    v_mul_f32 v160, s67, v160
    v_mul_f32 v161, s67, v161
    v_mul_f32 v162, s67, v162
    v_mul_f32 v163, s67, v163
    ds_read_b64_tr_b16 v[104:105], v28 offset:28672
    ds_read_b64_tr_b16 v[106:107], v28 offset:28928
    ds_read_b64_tr_b16 v[108:109], v29 offset:28672
    ds_read_b64_tr_b16 v[110:111], v29 offset:28928
    s_waitcnt lgkmcnt(6)
    v_mfma_f32_16x16x32_bf16 v[96:99], v[84:87], v[112:115], v[96:99]
    v_add_f32 v124, 1.0, v124
    v_add_f32 v125, 1.0, v125
    v_add_f32 v126, 1.0, v126
    v_add_f32 v127, 1.0, v127
    s_waitcnt lgkmcnt(4)
    v_mfma_f32_16x16x32_bf16 v[100:103], v[84:87], v[116:119], v[100:103]
    v_add_f32 v128, 1.0, v128
    v_add_f32 v129, 1.0, v129
    v_add_f32 v130, 1.0, v130
    v_add_f32 v131, 1.0, v131
    ds_read_b64_tr_b16 v[112:113], v28 offset:30720
    ds_read_b64_tr_b16 v[114:115], v28 offset:30976
    ds_read_b64_tr_b16 v[116:117], v29 offset:30720
    ds_read_b64_tr_b16 v[118:119], v29 offset:30976
    s_waitcnt lgkmcnt(6)
    v_mfma_f32_16x16x32_bf16 v[96:99], v[88:91], v[104:107], v[96:99]
    v_rcp_f32 v124, v124
    v_rcp_f32 v125, v125
    v_rcp_f32 v126, v126
    v_rcp_f32 v127, v127
    s_waitcnt lgkmcnt(4)
    v_mfma_f32_16x16x32_bf16 v[100:103], v[88:91], v[108:111], v[100:103]
    v_rcp_f32 v128, v128
    v_rcp_f32 v129, v129
    v_rcp_f32 v130, v130
    v_rcp_f32 v131, v131
    s_waitcnt lgkmcnt(2)
    v_mfma_f32_16x16x32_bf16 v[96:99], v[92:95], v[112:115], v[96:99]
    v_mul_f32 v156, v156, v124
    v_mul_f32 v157, v157, v125
    v_mul_f32 v158, v158, v126
    v_mul_f32 v159, v159, v127
    s_waitcnt lgkmcnt(0)
    v_mfma_f32_16x16x32_bf16 v[100:103], v[92:95], v[116:119], v[100:103]
    v_mul_f32 v160, v160, v128
    v_mul_f32 v161, v161, v129
    v_mul_f32 v162, v162, v130
    v_mul_f32 v163, v163, v131
    v_mul_f32 v96, v96, v156
    v_mul_f32 v97, v97, v157
    v_mul_f32 v98, v98, v158
    v_mul_f32 v99, v99, v159
    v_mul_f32 v100, v100, v160
    v_mul_f32 v101, v101, v161
    v_mul_f32 v102, v102, v162
    v_mul_f32 v103, v103, v163
    v_cvt_pk_bf16_f32 v124, v96, v97
    v_cvt_pk_bf16_f32 v125, v98, v99
    v_cvt_pk_bf16_f32 v126, v100, v101
    v_cvt_pk_bf16_f32 v127, v102, v103
    ds_write_b64 v14, v[124:125] offset:0
    ds_write_b64 v14, v[126:127] offset:4352
    s_waitcnt vmcnt(0)
    v_lshlrev_b32 v156, 16, v120
    v_and_b32 v157, s66, v120
    v_lshlrev_b32 v158, 16, v121
    v_and_b32 v159, s66, v121
    v_lshlrev_b32 v160, 16, v122
    v_and_b32 v161, s66, v122
    v_lshlrev_b32 v162, 16, v123
    v_and_b32 v163, s66, v123
    s_waitcnt lgkmcnt(0)
    s_barrier
    ds_read_b128 v[124:127], v15
    s_waitcnt lgkmcnt(0)
    v_lshlrev_b32 v128, 16, v124
    v_and_b32 v129, s66, v124
    v_add_f32 v128, v128, v156
    v_add_f32 v129, v129, v157
    v_cvt_pk_bf16_f32 v96, v128, v129
    v_lshlrev_b32 v130, 16, v125
    v_and_b32 v131, s66, v125
    v_add_f32 v130, v130, v158
    v_add_f32 v131, v131, v159
    v_cvt_pk_bf16_f32 v97, v130, v131
    v_lshlrev_b32 v132, 16, v126
    v_and_b32 v133, s66, v126
    v_add_f32 v132, v132, v160
    v_add_f32 v133, v133, v161
    v_cvt_pk_bf16_f32 v98, v132, v133
    v_lshlrev_b32 v134, 16, v127
    v_and_b32 v135, s66, v127
    v_add_f32 v134, v134, v162
    v_add_f32 v135, v135, v163
    v_cvt_pk_bf16_f32 v99, v134, v135
    buffer_store_dwordx4 v[96:99], v12, s[40:43], s63 offen
END_k3_kernel:
    s_endpgm
CODE_END:
.section .rodata,"a"
.p2align 6
.amdhsa_kernel k1_kernel
  .amdhsa_next_free_vgpr 256
  .amdhsa_next_free_sgpr 100
  .amdhsa_accum_offset 256
  .amdhsa_group_segment_fixed_size 0
  .amdhsa_kernarg_size 72
  .amdhsa_user_sgpr_count 2
  .amdhsa_user_sgpr_kernarg_segment_ptr 1
  .amdhsa_system_sgpr_workgroup_id_x 1
.end_amdhsa_kernel
.p2align 6
.amdhsa_kernel k2_kernel
  .amdhsa_next_free_vgpr 236
  .amdhsa_next_free_sgpr 80
  .amdhsa_accum_offset 236
  .amdhsa_group_segment_fixed_size 0
  .amdhsa_kernarg_size 72
  .amdhsa_user_sgpr_count 2
  .amdhsa_user_sgpr_kernarg_segment_ptr 1
  .amdhsa_system_sgpr_workgroup_id_x 1
.end_amdhsa_kernel
.p2align 6
.amdhsa_kernel k3_kernel
  .amdhsa_next_free_vgpr 180
  .amdhsa_next_free_sgpr 76
  .amdhsa_accum_offset 180
  .amdhsa_group_segment_fixed_size 0
  .amdhsa_kernarg_size 72
  .amdhsa_user_sgpr_count 2
  .amdhsa_user_sgpr_kernarg_segment_ptr 1
  .amdhsa_system_sgpr_workgroup_id_x 1
.end_amdhsa_kernel
.set CS0, 0x3f80
.set CS1, 0x3f80
.set CS2, 0x3f80
.set CS3, 0x3f80
.set CS4, 0x3f80
.set CS5, 0x3f80
.set CS6, 0x3f7f
.set CS7, 0x3f7f
.set CS8, 0x3f7f
.set CS9, 0x3f7e
.set CS10, 0x3f7e
.set CS11, 0x3f7e
.set CS12, 0x3f7d
.set CS13, 0x3f7d
.set CS14, 0x3f7c
.set CS15, 0x3f7c
.set CS16, 0x3f7b
.set CS17, 0x3f7a
.set CS18, 0x3f7a
.set CS19, 0x3f79
.set CS20, 0x3f78
.set CS21, 0x3f78
.set CS22, 0x3f77
.set CS23, 0x3f76
.set CS24, 0x3f75
.set CS25, 0x3f74
.set CS26, 0x3f73
.set CS27, 0x3f72
.set CS28, 0x3f71
.set CS29, 0x3f70
.set CS30, 0x3f6f
.set CS31, 0x3f6e
.set CS32, 0x3f6d
.set CS33, 0x3f6b
.set CS34, 0x3f6a
.set CS35, 0x3f69
.set CS36, 0x3f67
.set CS37, 0x3f66
.set CS38, 0x3f65
.set CS39, 0x3f63
.set CS40, 0x3f62
.set CS41, 0x3f60
.set CS42, 0x3f5f
.set CS43, 0x3f5d
.set CS44, 0x3f5c
.set CS45, 0x3f5a
.set CS46, 0x3f58
.set CS47, 0x3f57
.set CS48, 0x3f55
.set CS49, 0x3f53
.set CS50, 0x3f51
.set CS51, 0x3f4f
.set CS52, 0x3f4e
.set CS53, 0x3f4c
.set CS54, 0x3f4a
.set CS55, 0x3f48
.set CS56, 0x3f46
.set CS57, 0x3f44
.set CS58, 0x3f42
.set CS59, 0x3f40
.set CS60, 0x3f3e
.set CS61, 0x3f3c
.set CS62, 0x3f39
.set CS63, 0x3f37
.set CS64, 0x3f35
.set CS65, 0x3f33
.set CS66, 0x3f31
.set CS67, 0x3f2e
.set CS68, 0x3f2c
.set CS69, 0x3f2a
.set CS70, 0x3f27
.set CS71, 0x3f25
.set CS72, 0x3f22
.set CS73, 0x3f20
.set CS74, 0x3f1d
.set CS75, 0x3f1b
.set CS76, 0x3f18
.set CS77, 0x3f16
.set CS78, 0x3f13
.set CS79, 0x3f11
.set CS80, 0x3f0e
.set CS81, 0x3f0c
.set CS82, 0x3f09
.set CS83, 0x3f06
.set CS84, 0x3f04
.set CS85, 0x3f01
.set CS86, 0x3efc
.set CS87, 0x3ef7
.set CS88, 0x3ef1
.set CS89, 0x3eec
.set CS90, 0x3ee6
.set CS91, 0x3ee1
.set CS92, 0x3edb
.set CS93, 0x3ed5
.set CS94, 0x3ecf
.set CS95, 0x3eca
.set CS96, 0x3ec4
.set CS97, 0x3ebe
.set CS98, 0x3eb8
.set CS99, 0x3eb2
.set CS100, 0x3eac
.set CS101, 0x3ea7
.set CS102, 0x3ea1
.set CS103, 0x3e9b
.set CS104, 0x3e95
.set CS105, 0x3e8f
.set CS106, 0x3e89
.set CS107, 0x3e82
.set CS108, 0x3e79
.set CS109, 0x3e6d
.set CS110, 0x3e60
.set CS111, 0x3e54
.set CS112, 0x3e48
.set CS113, 0x3e3b
.set CS114, 0x3e2f
.set CS115, 0x3e23
.set CS116, 0x3e16
.set CS117, 0x3e0a
.set CS118, 0x3dfb
.set CS119, 0x3de2
.set CS120, 0x3dc9
.set CS121, 0x3db0
.set CS122, 0x3d97
.set CS123, 0x3d7b
.set CS124, 0x3d49
.set CS125, 0x3d17
.set CS126, 0x3cc9
.set CS127, 0x3c49
.set CS128, 0x0
.set CS129, 0xbc49
.set CS130, 0xbcc9
.set CS131, 0xbd17
.set CS132, 0xbd49
.set CS133, 0xbd7b
.set CS134, 0xbd97
.set CS135, 0xbdb0
.set CS136, 0xbdc9
.set CS137, 0xbde2
.set CS138, 0xbdfb
.set CS139, 0xbe0a
.set CS140, 0xbe16
.set CS141, 0xbe23
.set CS142, 0xbe2f
.set CS143, 0xbe3b
.set CS144, 0xbe48
.set CS145, 0xbe54
.set CS146, 0xbe60
.set CS147, 0xbe6d
.set CS148, 0xbe79
.set CS149, 0xbe82
.set CS150, 0xbe89
.set CS151, 0xbe8f
.set CS152, 0xbe95
.set CS153, 0xbe9b
.set CS154, 0xbea1
.set CS155, 0xbea7
.set CS156, 0xbeac
.set CS157, 0xbeb2
.set CS158, 0xbeb8
.set CS159, 0xbebe
.set CS160, 0xbec4
.set CS161, 0xbeca
.set CS162, 0xbecf
.set CS163, 0xbed5
.set CS164, 0xbedb
.set CS165, 0xbee1
.set CS166, 0xbee6
.set CS167, 0xbeec
.set CS168, 0xbef1
.set CS169, 0xbef7
.set CS170, 0xbefc
.set CS171, 0xbf01
.set CS172, 0xbf04
.set CS173, 0xbf06
.set CS174, 0xbf09
.set CS175, 0xbf0c
.set CS176, 0xbf0e
.set CS177, 0xbf11
.set CS178, 0xbf13
.set CS179, 0xbf16
.set CS180, 0xbf18
.set CS181, 0xbf1b
.set CS182, 0xbf1d
.set CS183, 0xbf20
.set CS184, 0xbf22
.set CS185, 0xbf25
.set CS186, 0xbf27
.set CS187, 0xbf2a
.set CS188, 0xbf2c
.set CS189, 0xbf2e
.set CS190, 0xbf31
.set CS191, 0xbf33
.set CS192, 0xbf35
.set CS193, 0xbf37
.set CS194, 0xbf39
.set CS195, 0xbf3c
.set CS196, 0xbf3e
.set CS197, 0xbf40
.set CS198, 0xbf42
.set CS199, 0xbf44
.set CS200, 0xbf46
.set CS201, 0xbf48
.set CS202, 0xbf4a
.set CS203, 0xbf4c
.set CS204, 0xbf4e
.set CS205, 0xbf4f
.set CS206, 0xbf51
.set CS207, 0xbf53
.set CS208, 0xbf55
.set CS209, 0xbf57
.set CS210, 0xbf58
.set CS211, 0xbf5a
.set CS212, 0xbf5c
.set CS213, 0xbf5d
.set CS214, 0xbf5f
.set CS215, 0xbf60
.set CS216, 0xbf62
.set CS217, 0xbf63
.set CS218, 0xbf65
.set CS219, 0xbf66
.set CS220, 0xbf67
.set CS221, 0xbf69
.set CS222, 0xbf6a
.set CS223, 0xbf6b
.set CS224, 0xbf6d
.set CS225, 0xbf6e
.set CS226, 0xbf6f
.set CS227, 0xbf70
.set CS228, 0xbf71
.set CS229, 0xbf72
.set CS230, 0xbf73
.set CS231, 0xbf74
.set CS232, 0xbf75
.set CS233, 0xbf76
.set CS234, 0xbf77
.set CS235, 0xbf78
.set CS236, 0xbf78
.set CS237, 0xbf79
.set CS238, 0xbf7a
.set CS239, 0xbf7a
.set CS240, 0xbf7b
.set CS241, 0xbf7c
.set CS242, 0xbf7c
.set CS243, 0xbf7d
.set CS244, 0xbf7d
.set CS245, 0xbf7e
.set CS246, 0xbf7e
.set CS247, 0xbf7e
.set CS248, 0xbf7f
.set CS249, 0xbf7f
.set CS250, 0xbf7f
.set CS251, 0xbf80
.set CS252, 0xbf80
.set CS253, 0xbf80
.set CS254, 0xbf80
.set CS255, 0xbf80
.set CS256, 0xbf80
.set CS257, 0xbf80
.set CS258, 0xbf80
.set CS259, 0xbf80
.set CS260, 0xbf80
.set CS261, 0xbf80
.set CS262, 0xbf7f
.set CS263, 0xbf7f
.set CS264, 0xbf7f
.set CS265, 0xbf7e
.set CS266, 0xbf7e
.set CS267, 0xbf7e
.set CS268, 0xbf7d
.set CS269, 0xbf7d
.set CS270, 0xbf7c
.set CS271, 0xbf7c
.set CS272, 0xbf7b
.set CS273, 0xbf7a
.set CS274, 0xbf7a
.set CS275, 0xbf79
.set CS276, 0xbf78
.set CS277, 0xbf78
.set CS278, 0xbf77
.set CS279, 0xbf76
.set CS280, 0xbf75
.set CS281, 0xbf74
.set CS282, 0xbf73
.set CS283, 0xbf72
.set CS284, 0xbf71
.set CS285, 0xbf70
.set CS286, 0xbf6f
.set CS287, 0xbf6e
.set CS288, 0xbf6d
.set CS289, 0xbf6b
.set CS290, 0xbf6a
.set CS291, 0xbf69
.set CS292, 0xbf67
.set CS293, 0xbf66
.set CS294, 0xbf65
.set CS295, 0xbf63
.set CS296, 0xbf62
.set CS297, 0xbf60
.set CS298, 0xbf5f
.set CS299, 0xbf5d
.set CS300, 0xbf5c
.set CS301, 0xbf5a
.set CS302, 0xbf58
.set CS303, 0xbf57
.set CS304, 0xbf55
.set CS305, 0xbf53
.set CS306, 0xbf51
.set CS307, 0xbf4f
.set CS308, 0xbf4e
.set CS309, 0xbf4c
.set CS310, 0xbf4a
.set CS311, 0xbf48
.set CS312, 0xbf46
.set CS313, 0xbf44
.set CS314, 0xbf42
.set CS315, 0xbf40
.set CS316, 0xbf3e
.set CS317, 0xbf3c
.set CS318, 0xbf39
.set CS319, 0xbf37
.set CS320, 0xbf35
.set CS321, 0xbf33
.set CS322, 0xbf31
.set CS323, 0xbf2e
.set CS324, 0xbf2c
.set CS325, 0xbf2a
.set CS326, 0xbf27
.set CS327, 0xbf25
.set CS328, 0xbf22
.set CS329, 0xbf20
.set CS330, 0xbf1d
.set CS331, 0xbf1b
.set CS332, 0xbf18
.set CS333, 0xbf16
.set CS334, 0xbf13
.set CS335, 0xbf11
.set CS336, 0xbf0e
.set CS337, 0xbf0c
.set CS338, 0xbf09
.set CS339, 0xbf06
.set CS340, 0xbf04
.set CS341, 0xbf01
.set CS342, 0xbefc
.set CS343, 0xbef7
.set CS344, 0xbef1
.set CS345, 0xbeec
.set CS346, 0xbee6
.set CS347, 0xbee1
.set CS348, 0xbedb
.set CS349, 0xbed5
.set CS350, 0xbecf
.set CS351, 0xbeca
.set CS352, 0xbec4
.set CS353, 0xbebe
.set CS354, 0xbeb8
.set CS355, 0xbeb2
.set CS356, 0xbeac
.set CS357, 0xbea7
.set CS358, 0xbea1
.set CS359, 0xbe9b
.set CS360, 0xbe95
.set CS361, 0xbe8f
.set CS362, 0xbe89
.set CS363, 0xbe82
.set CS364, 0xbe79
.set CS365, 0xbe6d
.set CS366, 0xbe60
.set CS367, 0xbe54
.set CS368, 0xbe48
.set CS369, 0xbe3b
.set CS370, 0xbe2f
.set CS371, 0xbe23
.set CS372, 0xbe16
.set CS373, 0xbe0a
.set CS374, 0xbdfb
.set CS375, 0xbde2
.set CS376, 0xbdc9
.set CS377, 0xbdb0
.set CS378, 0xbd97
.set CS379, 0xbd7b
.set CS380, 0xbd49
.set CS381, 0xbd17
.set CS382, 0xbcc9
.set CS383, 0xbc49
.set CS384, 0x0
.set CS385, 0x3c49
.set CS386, 0x3cc9
.set CS387, 0x3d17
.set CS388, 0x3d49
.set CS389, 0x3d7b
.set CS390, 0x3d97
.set CS391, 0x3db0
.set CS392, 0x3dc9
.set CS393, 0x3de2
.set CS394, 0x3dfb
.set CS395, 0x3e0a
.set CS396, 0x3e16
.set CS397, 0x3e23
.set CS398, 0x3e2f
.set CS399, 0x3e3b
.set CS400, 0x3e48
.set CS401, 0x3e54
.set CS402, 0x3e60
.set CS403, 0x3e6d
.set CS404, 0x3e79
.set CS405, 0x3e82
.set CS406, 0x3e89
.set CS407, 0x3e8f
.set CS408, 0x3e95
.set CS409, 0x3e9b
.set CS410, 0x3ea1
.set CS411, 0x3ea7
.set CS412, 0x3eac
.set CS413, 0x3eb2
.set CS414, 0x3eb8
.set CS415, 0x3ebe
.set CS416, 0x3ec4
.set CS417, 0x3eca
.set CS418, 0x3ecf
.set CS419, 0x3ed5
.set CS420, 0x3edb
.set CS421, 0x3ee1
.set CS422, 0x3ee6
.set CS423, 0x3eec
.set CS424, 0x3ef1
.set CS425, 0x3ef7
.set CS426, 0x3efc
.set CS427, 0x3f01
.set CS428, 0x3f04
.set CS429, 0x3f06
.set CS430, 0x3f09
.set CS431, 0x3f0c
.set CS432, 0x3f0e
.set CS433, 0x3f11
.set CS434, 0x3f13
.set CS435, 0x3f16
.set CS436, 0x3f18
.set CS437, 0x3f1b
.set CS438, 0x3f1d
.set CS439, 0x3f20
.set CS440, 0x3f22
.set CS441, 0x3f25
.set CS442, 0x3f27
.set CS443, 0x3f2a
.set CS444, 0x3f2c
.set CS445, 0x3f2e
.set CS446, 0x3f31
.set CS447, 0x3f33
.set CS448, 0x3f35
.set CS449, 0x3f37
.set CS450, 0x3f39
.set CS451, 0x3f3c
.set CS452, 0x3f3e
.set CS453, 0x3f40
.set CS454, 0x3f42
.set CS455, 0x3f44
.set CS456, 0x3f46
.set CS457, 0x3f48
.set CS458, 0x3f4a
.set CS459, 0x3f4c
.set CS460, 0x3f4e
.set CS461, 0x3f4f
.set CS462, 0x3f51
.set CS463, 0x3f53
.set CS464, 0x3f55
.set CS465, 0x3f57
.set CS466, 0x3f58
.set CS467, 0x3f5a
.set CS468, 0x3f5c
.set CS469, 0x3f5d
.set CS470, 0x3f5f
.set CS471, 0x3f60
.set CS472, 0x3f62
.set CS473, 0x3f63
.set CS474, 0x3f65
.set CS475, 0x3f66
.set CS476, 0x3f67
.set CS477, 0x3f69
.set CS478, 0x3f6a
.set CS479, 0x3f6b
.set CS480, 0x3f6d
.set CS481, 0x3f6e
.set CS482, 0x3f6f
.set CS483, 0x3f70
.set CS484, 0x3f71
.set CS485, 0x3f72
.set CS486, 0x3f73
.set CS487, 0x3f74
.set CS488, 0x3f75
.set CS489, 0x3f76
.set CS490, 0x3f77
.set CS491, 0x3f78
.set CS492, 0x3f78
.set CS493, 0x3f79
.set CS494, 0x3f7a
.set CS495, 0x3f7a
.set CS496, 0x3f7b
.set CS497, 0x3f7c
.set CS498, 0x3f7c
.set CS499, 0x3f7d
.set CS500, 0x3f7d
.set CS501, 0x3f7e
.set CS502, 0x3f7e
.set CS503, 0x3f7e
.set CS504, 0x3f7f
.set CS505, 0x3f7f
.set CS506, 0x3f7f
.set CS507, 0x3f80
.set CS508, 0x3f80
.set CS509, 0x3f80
.set CS510, 0x3f80
.set CS511, 0x3f80
.altmacro
.macro EMITCS i
.short CS\i
.endm
.p2align 8
.type FB2,@object
FB2:
.set ff, 0
.rept 256
.set ll, 0
.rept 64
.set kk, 2*(8*(ff & 15) + ((ll & 15) >> 1)) + 2 - (ff >> 7)
.set ang, ((32*((ff >> 4) & 7) + 8*(ll >> 4))*kk + 128*(ll & 1)) & 511
.rept 8
EMITCS %ang
.set ang, (ang + kk) & 511
.endr
.set ll, ll + 1
.endr
.set ff, ff + 1
.endr
.size FB2, 262144
.noaltmacro
.type CTAB,@object
CTAB:
.long 0x3d003d00,0x3d003d00,0x3d003d00,0x3d003d00,0x3cfb3d00,0x3cd53ced,0xbcfbbd00,0xbcd5bced
.long 0x3ced3d00,0x3c443cb5,0x3ced3d00,0x3c443cb5,0x3cd53d00,0xbbc83c44,0xbcd5bd00,0x3bc8bc44
.long 0x3cb53d00,0xbcb50000,0x3cb53d00,0xbcb50000,0x3c8e3d00,0xbcfbbc44,0xbc8ebd00,0x3cfb3c44
.long 0x3c443d00,0xbcedbcb5,0x3c443d00,0xbcedbcb5,0x3bc83d00,0xbc8ebced,0xbbc8bd00,0x3c8e3ced
.long 0x3d00,0xbd00,0x3d00,0xbd00,0xbbc83d00,0x3c8ebced,0x3bc8bd00,0xbc8e3ced
.long 0xbc443d00,0x3cedbcb5,0xbc443d00,0x3cedbcb5,0xbc8e3d00,0x3cfbbc44,0x3c8ebd00,0xbcfb3c44
.long 0xbcb53d00,0x3cb50000,0xbcb53d00,0x3cb50000,0xbcd53d00,0x3bc83c44,0x3cd5bd00,0xbbc8bc44
.long 0xbced3d00,0xbc443cb5,0xbced3d00,0xbc443cb5,0xbcfb3d00,0xbcd53ced,0x3cfbbd00,0x3cd5bced
.long 0x3d003d00,0x3d003d00,0x3d003d00,0x3d003d00,0x3c8e3cb5,0x3bc83c44,0xbc8ebcb5,0xbbc8bc44
.long 0xbc440000,0xbcedbcb5,0xbc440000,0xbcedbcb5,0xbcfbbcb5,0xbc8ebced,0x3cfb3cb5,0x3c8e3ced
.long 0xbcb5bd00,0x3cb50000,0xbcb5bd00,0x3cb50000,0x3bc8bcb5,0x3cd53ced,0xbbc83cb5,0xbcd5bced
.long 0x3ced0000,0xbc443cb5,0x3ced0000,0xbc443cb5,0x3cd53cb5,0xbcfbbc44,0xbcd5bcb5,0x3cfb3c44
.long 0x3d00,0xbd00,0x3d00,0xbd00,0xbcd53cb5,0x3cfbbc44,0x3cd5bcb5,0xbcfb3c44
.long 0xbced0000,0x3c443cb5,0xbced0000,0x3c443cb5,0xbbc8bcb5,0xbcd53ced,0x3bc83cb5,0x3cd5bced
.long 0x3cb5bd00,0xbcb50000,0x3cb5bd00,0xbcb50000,0x3cfbbcb5,0x3c8ebced,0xbcfb3cb5,0xbc8e3ced
.long 0x3c440000,0x3cedbcb5,0x3c440000,0x3cedbcb5,0xbc8e3cb5,0xbbc83c44,0x3c8ebcb5,0x3bc8bc44
.long 0x3d003d00,0x3d003d00,0x3d003d00,0x3d003d00,0xbbc80000,0xbc8ebc44,0x3bc80000,0x3c8e3c44
.long 0xbcedbd00,0xbc44bcb5,0xbcedbd00,0xbc44bcb5,0x3c8e0000,0x3cfb3ced,0xbc8e0000,0xbcfbbced
.long 0x3cb53d00,0xbcb50000,0x3cb53d00,0xbcb50000,0xbcd50000,0xbbc8bced,0x3cd50000,0x3bc83ced
.long 0xbc44bd00,0x3ced3cb5,0xbc44bd00,0x3ced3cb5,0x3cfb0000,0xbcd53c44,0xbcfb0000,0x3cd5bc44
.long 0x3d00,0xbd00,0x3d00,0xbd00,0xbcfb0000,0x3cd53c44,0x3cfb0000,0xbcd5bc44
.long 0x3c44bd00,0xbced3cb5,0x3c44bd00,0xbced3cb5,0x3cd50000,0x3bc8bced,0xbcd50000,0xbbc83ced
.long 0xbcb53d00,0x3cb50000,0xbcb53d00,0x3cb50000,0xbc8e0000,0xbcfb3ced,0x3c8e0000,0x3cfbbced
.long 0x3cedbd00,0x3c44bcb5,0x3cedbd00,0x3c44bcb5,0x3bc80000,0x3c8ebc44,0xbbc80000,0xbc8e3c44
.long 0x3d003d00,0x3d003d00,0x3d003d00,0x3d003d00,0xbcd5bcb5,0xbcfbbced,0x3cd53cb5,0x3cfb3ced
.long 0x3c440000,0x3ced3cb5,0x3c440000,0x3ced3cb5,0x3bc83cb5,0xbcd5bc44,0xbbc8bcb5,0x3cd53c44
.long 0xbcb5bd00,0x3cb50000,0xbcb5bd00,0x3cb50000,0x3cfb3cb5,0xbc8e3c44,0xbcfbbcb5,0x3c8ebc44
.long 0xbced0000,0x3c44bcb5,0xbced0000,0x3c44bcb5,0x3c8ebcb5,0xbbc83ced,0xbc8e3cb5,0x3bc8bced
.long 0x3d00,0xbd00,0x3d00,0xbd00,0xbc8ebcb5,0x3bc83ced,0x3c8e3cb5,0xbbc8bced
.long 0x3ced0000,0xbc44bcb5,0x3ced0000,0xbc44bcb5,0xbcfb3cb5,0x3c8e3c44,0x3cfbbcb5,0xbc8ebc44
.long 0x3cb5bd00,0xbcb50000,0x3cb5bd00,0xbcb50000,0xbbc83cb5,0x3cd5bc44,0x3bc8bcb5,0xbcd53c44
.long 0xbc440000,0xbced3cb5,0xbc440000,0xbced3cb5,0x3cd5bcb5,0x3cfbbced,0xbcd53cb5,0xbcfb3ced
.long 0xbd003d00,0xbd003d00,0xbd003d00,0xbd003d00,0xbcfb3d00,0xbcd53ced,0x3cfbbd00,0x3cd5bced
.long 0xbced3d00,0xbc443cb5,0xbced3d00,0xbc443cb5,0xbcd53d00,0x3bc83c44,0x3cd5bd00,0xbbc8bc44
.long 0xbcb53d00,0x3cb50000,0xbcb53d00,0x3cb50000,0xbc8e3d00,0x3cfbbc44,0x3c8ebd00,0xbcfb3c44
.long 0xbc443d00,0x3cedbcb5,0xbc443d00,0x3cedbcb5,0xbbc83d00,0x3c8ebced,0x3bc8bd00,0xbc8e3ced
.long 0x3d00,0xbd00,0x3d00,0xbd00,0x3bc83d00,0xbc8ebced,0xbbc8bd00,0x3c8e3ced
.long 0x3c443d00,0xbcedbcb5,0x3c443d00,0xbcedbcb5,0x3c8e3d00,0xbcfbbc44,0xbc8ebd00,0x3cfb3c44
.long 0x3cb53d00,0xbcb50000,0x3cb53d00,0xbcb50000,0x3cd53d00,0xbbc83c44,0xbcd5bd00,0x3bc8bc44
.long 0x3ced3d00,0x3c443cb5,0x3ced3d00,0x3c443cb5,0x3cfb3d00,0x3cd53ced,0xbcfbbd00,0xbcd5bced
.long 0xbd003d00,0xbd003d00,0xbd003d00,0xbd003d00,0xbc8e3cb5,0xbbc83c44,0x3c8ebcb5,0x3bc8bc44
.long 0x3c440000,0x3cedbcb5,0x3c440000,0x3cedbcb5,0x3cfbbcb5,0x3c8ebced,0xbcfb3cb5,0xbc8e3ced
.long 0x3cb5bd00,0xbcb50000,0x3cb5bd00,0xbcb50000,0xbbc8bcb5,0xbcd53ced,0x3bc83cb5,0x3cd5bced
.long 0xbced0000,0x3c443cb5,0xbced0000,0x3c443cb5,0xbcd53cb5,0x3cfbbc44,0x3cd5bcb5,0xbcfb3c44
.long 0x3d00,0xbd00,0x3d00,0xbd00,0x3cd53cb5,0xbcfbbc44,0xbcd5bcb5,0x3cfb3c44
.long 0x3ced0000,0xbc443cb5,0x3ced0000,0xbc443cb5,0x3bc8bcb5,0x3cd53ced,0xbbc83cb5,0xbcd5bced
.long 0xbcb5bd00,0x3cb50000,0xbcb5bd00,0x3cb50000,0xbcfbbcb5,0xbc8ebced,0x3cfb3cb5,0x3c8e3ced
.long 0xbc440000,0xbcedbcb5,0xbc440000,0xbcedbcb5,0x3c8e3cb5,0x3bc83c44,0xbc8ebcb5,0xbbc8bc44
.long 0xbd003d00,0xbd003d00,0xbd003d00,0xbd003d00,0x3bc80000,0x3c8ebc44,0xbbc80000,0xbc8e3c44
.long 0x3cedbd00,0x3c44bcb5,0x3cedbd00,0x3c44bcb5,0xbc8e0000,0xbcfb3ced,0x3c8e0000,0x3cfbbced
.long 0xbcb53d00,0x3cb50000,0xbcb53d00,0x3cb50000,0x3cd50000,0x3bc8bced,0xbcd50000,0xbbc83ced
.long 0x3c44bd00,0xbced3cb5,0x3c44bd00,0xbced3cb5,0xbcfb0000,0x3cd53c44,0x3cfb0000,0xbcd5bc44
.long 0x3d00,0xbd00,0x3d00,0xbd00,0x3cfb0000,0xbcd53c44,0xbcfb0000,0x3cd5bc44
.long 0xbc44bd00,0x3ced3cb5,0xbc44bd00,0x3ced3cb5,0xbcd50000,0xbbc8bced,0x3cd50000,0x3bc83ced
.long 0x3cb53d00,0xbcb50000,0x3cb53d00,0xbcb50000,0x3c8e0000,0x3cfb3ced,0xbc8e0000,0xbcfbbced
.long 0xbcedbd00,0xbc44bcb5,0xbcedbd00,0xbc44bcb5,0xbbc80000,0xbc8ebc44,0x3bc80000,0x3c8e3c44
.long 0xbd003d00,0xbd003d00,0xbd003d00,0xbd003d00,0x3cd5bcb5,0x3cfbbced,0xbcd53cb5,0xbcfb3ced
.long 0xbc440000,0xbced3cb5,0xbc440000,0xbced3cb5,0xbbc83cb5,0x3cd5bc44,0x3bc8bcb5,0xbcd53c44
.long 0x3cb5bd00,0xbcb50000,0x3cb5bd00,0xbcb50000,0xbcfb3cb5,0x3c8e3c44,0x3cfbbcb5,0xbc8ebc44
.long 0x3ced0000,0xbc44bcb5,0x3ced0000,0xbc44bcb5,0xbc8ebcb5,0x3bc83ced,0x3c8e3cb5,0xbbc8bced
.long 0x3d00,0xbd00,0x3d00,0xbd00,0x3c8ebcb5,0xbbc83ced,0xbc8e3cb5,0x3bc8bced
.long 0xbced0000,0x3c44bcb5,0xbced0000,0x3c44bcb5,0x3cfb3cb5,0xbc8e3c44,0xbcfbbcb5,0x3c8ebc44
.long 0xbcb5bd00,0x3cb50000,0xbcb5bd00,0x3cb50000,0x3bc83cb5,0xbcd5bc44,0xbbc8bcb5,0x3cd53c44
.long 0x3c440000,0x3ced3cb5,0x3c440000,0x3ced3cb5,0xbcd5bcb5,0xbcfbbced,0x3cd53cb5,0x3cfb3ced
.long 0x0,0x0,0x0,0x0,0x3bc80000,0x3c8e3c44,0xbbc80000,0xbc8ebc44
.long 0x3c440000,0x3ced3cb5,0x3c440000,0x3ced3cb5,0x3c8e0000,0x3cfb3ced,0xbc8e0000,0xbcfbbced
.long 0x3cb50000,0x3cb53d00,0x3cb50000,0x3cb53d00,0x3cd50000,0x3bc83ced,0xbcd50000,0xbbc8bced
.long 0x3ced0000,0xbc443cb5,0x3ced0000,0xbc443cb5,0x3cfb0000,0xbcd53c44,0xbcfb0000,0x3cd5bc44
.long 0x3d000000,0xbd000000,0x3d000000,0xbd000000,0x3cfb0000,0xbcd5bc44,0xbcfb0000,0x3cd53c44
.long 0x3ced0000,0xbc44bcb5,0x3ced0000,0xbc44bcb5,0x3cd50000,0x3bc8bced,0xbcd50000,0xbbc83ced
.long 0x3cb50000,0x3cb5bd00,0x3cb50000,0x3cb5bd00,0x3c8e0000,0x3cfbbced,0xbc8e0000,0xbcfb3ced
.long 0x3c440000,0x3cedbcb5,0x3c440000,0x3cedbcb5,0x3bc80000,0x3c8ebc44,0xbbc80000,0xbc8e3c44
.long 0x0,0x0,0x0,0x0,0x3cd53cb5,0x3cfb3ced,0xbcd5bcb5,0xbcfbbced
.long 0x3ced3d00,0x3c443cb5,0x3ced3d00,0x3c443cb5,0x3bc83cb5,0xbcd5bc44,0xbbc8bcb5,0x3cd53c44
.long 0xbcb50000,0xbcb5bd00,0xbcb50000,0xbcb5bd00,0xbcfbbcb5,0x3c8ebc44,0x3cfb3cb5,0xbc8e3c44
.long 0xbc44bd00,0x3ced3cb5,0xbc44bd00,0x3ced3cb5,0x3c8ebcb5,0xbbc83ced,0xbc8e3cb5,0x3bc8bced
.long 0x3d000000,0xbd000000,0x3d000000,0xbd000000,0x3c8e3cb5,0xbbc8bced,0xbc8ebcb5,0x3bc83ced
.long 0xbc443d00,0x3cedbcb5,0xbc443d00,0x3cedbcb5,0xbcfb3cb5,0x3c8e3c44,0x3cfbbcb5,0xbc8ebc44
.long 0xbcb50000,0xbcb53d00,0xbcb50000,0xbcb53d00,0x3bc8bcb5,0xbcd53c44,0xbbc83cb5,0x3cd5bc44
.long 0x3cedbd00,0x3c44bcb5,0x3cedbd00,0x3c44bcb5,0x3cd5bcb5,0x3cfbbced,0xbcd53cb5,0xbcfb3ced
.long 0x0,0x0,0x0,0x0,0x3cfb3d00,0x3cd53ced,0xbcfbbd00,0xbcd5bced
.long 0xbc440000,0xbcedbcb5,0xbc440000,0xbcedbcb5,0xbcd5bd00,0x3bc8bc44,0x3cd53d00,0xbbc83c44
.long 0x3cb50000,0x3cb53d00,0x3cb50000,0x3cb53d00,0x3c8e3d00,0xbcfbbc44,0xbc8ebd00,0x3cfb3c44
.long 0xbced0000,0x3c44bcb5,0xbced0000,0x3c44bcb5,0xbbc8bd00,0x3c8e3ced,0x3bc83d00,0xbc8ebced
.long 0x3d000000,0xbd000000,0x3d000000,0xbd000000,0xbbc83d00,0x3c8ebced,0x3bc8bd00,0xbc8e3ced
.long 0xbced0000,0x3c443cb5,0xbced0000,0x3c443cb5,0x3c8ebd00,0xbcfb3c44,0xbc8e3d00,0x3cfbbc44
.long 0x3cb50000,0x3cb5bd00,0x3cb50000,0x3cb5bd00,0xbcd53d00,0x3bc83c44,0x3cd5bd00,0xbbc8bc44
.long 0xbc440000,0xbced3cb5,0xbc440000,0xbced3cb5,0x3cfbbd00,0x3cd5bced,0xbcfb3d00,0xbcd53ced
.long 0x0,0x0,0x0,0x0,0x3c8e3cb5,0x3bc83c44,0xbc8ebcb5,0xbbc8bc44
.long 0xbcedbd00,0xbc44bcb5,0xbcedbd00,0xbc44bcb5,0x3cfb3cb5,0x3c8e3ced,0xbcfbbcb5,0xbc8ebced
.long 0xbcb50000,0xbcb5bd00,0xbcb50000,0xbcb5bd00,0x3bc8bcb5,0x3cd53ced,0xbbc83cb5,0xbcd5bced
.long 0x3c443d00,0xbcedbcb5,0x3c443d00,0xbcedbcb5,0xbcd5bcb5,0x3cfb3c44,0x3cd53cb5,0xbcfbbc44
.long 0x3d000000,0xbd000000,0x3d000000,0xbd000000,0xbcd53cb5,0x3cfbbc44,0x3cd5bcb5,0xbcfb3c44
.long 0x3c44bd00,0xbced3cb5,0x3c44bd00,0xbced3cb5,0x3bc83cb5,0x3cd5bced,0xbbc8bcb5,0xbcd53ced
.long 0xbcb50000,0xbcb53d00,0xbcb50000,0xbcb53d00,0x3cfbbcb5,0x3c8ebced,0xbcfb3cb5,0xbc8e3ced
.long 0xbced3d00,0xbc443cb5,0xbced3d00,0xbc443cb5,0x3c8ebcb5,0x3bc8bc44,0xbc8e3cb5,0xbbc83c44
.long 0x0,0x0,0x0,0x0,0xbbc80000,0xbc8e3c44,0x3bc80000,0x3c8ebc44
.long 0xbc440000,0xbced3cb5,0xbc440000,0xbced3cb5,0xbc8e0000,0xbcfb3ced,0x3c8e0000,0x3cfbbced
.long 0xbcb50000,0xbcb53d00,0xbcb50000,0xbcb53d00,0xbcd50000,0xbbc83ced,0x3cd50000,0x3bc8bced
.long 0xbced0000,0x3c443cb5,0xbced0000,0x3c443cb5,0xbcfb0000,0x3cd53c44,0x3cfb0000,0xbcd5bc44
.long 0xbd000000,0x3d000000,0xbd000000,0x3d000000,0xbcfb0000,0x3cd5bc44,0x3cfb0000,0xbcd53c44
.long 0xbced0000,0x3c44bcb5,0xbced0000,0x3c44bcb5,0xbcd50000,0xbbc8bced,0x3cd50000,0x3bc83ced
.long 0xbcb50000,0xbcb5bd00,0xbcb50000,0xbcb5bd00,0xbc8e0000,0xbcfbbced,0x3c8e0000,0x3cfb3ced
.long 0xbc440000,0xbcedbcb5,0xbc440000,0xbcedbcb5,0xbbc80000,0xbc8ebc44,0x3bc80000,0x3c8e3c44
.long 0x0,0x0,0x0,0x0,0xbcd53cb5,0xbcfb3ced,0x3cd5bcb5,0x3cfbbced
.long 0xbced3d00,0xbc443cb5,0xbced3d00,0xbc443cb5,0xbbc83cb5,0x3cd5bc44,0x3bc8bcb5,0xbcd53c44
.long 0x3cb50000,0x3cb5bd00,0x3cb50000,0x3cb5bd00,0x3cfbbcb5,0xbc8ebc44,0xbcfb3cb5,0x3c8e3c44
.long 0x3c44bd00,0xbced3cb5,0x3c44bd00,0xbced3cb5,0xbc8ebcb5,0x3bc83ced,0x3c8e3cb5,0xbbc8bced
.long 0xbd000000,0x3d000000,0xbd000000,0x3d000000,0xbc8e3cb5,0x3bc8bced,0x3c8ebcb5,0xbbc83ced
.long 0x3c443d00,0xbcedbcb5,0x3c443d00,0xbcedbcb5,0x3cfb3cb5,0xbc8e3c44,0xbcfbbcb5,0x3c8ebc44
.long 0x3cb50000,0x3cb53d00,0x3cb50000,0x3cb53d00,0xbbc8bcb5,0x3cd53c44,0x3bc83cb5,0xbcd5bc44
.long 0xbcedbd00,0xbc44bcb5,0xbcedbd00,0xbc44bcb5,0xbcd5bcb5,0xbcfbbced,0x3cd53cb5,0x3cfb3ced
.long 0x0,0x0,0x0,0x0,0xbcfb3d00,0xbcd53ced,0x3cfbbd00,0x3cd5bced
.long 0x3c440000,0x3cedbcb5,0x3c440000,0x3cedbcb5,0x3cd5bd00,0xbbc8bc44,0xbcd53d00,0x3bc83c44
.long 0xbcb50000,0xbcb53d00,0xbcb50000,0xbcb53d00,0xbc8e3d00,0x3cfbbc44,0x3c8ebd00,0xbcfb3c44
.long 0x3ced0000,0xbc44bcb5,0x3ced0000,0xbc44bcb5,0x3bc8bd00,0xbc8e3ced,0xbbc83d00,0x3c8ebced
.long 0xbd000000,0x3d000000,0xbd000000,0x3d000000,0x3bc83d00,0xbc8ebced,0xbbc8bd00,0x3c8e3ced
.long 0x3ced0000,0xbc443cb5,0x3ced0000,0xbc443cb5,0xbc8ebd00,0x3cfb3c44,0x3c8e3d00,0xbcfbbc44
.long 0xbcb50000,0xbcb5bd00,0xbcb50000,0xbcb5bd00,0x3cd53d00,0xbbc83c44,0xbcd5bd00,0x3bc8bc44
.long 0x3c440000,0x3ced3cb5,0x3c440000,0x3ced3cb5,0xbcfbbd00,0xbcd5bced,0x3cfb3d00,0x3cd53ced
.long 0x0,0x0,0x0,0x0,0xbc8e3cb5,0xbbc83c44,0x3c8ebcb5,0x3bc8bc44
.long 0x3cedbd00,0x3c44bcb5,0x3cedbd00,0x3c44bcb5,0xbcfb3cb5,0xbc8e3ced,0x3cfbbcb5,0x3c8ebced
.long 0x3cb50000,0x3cb5bd00,0x3cb50000,0x3cb5bd00,0xbbc8bcb5,0xbcd53ced,0x3bc83cb5,0x3cd5bced
.long 0xbc443d00,0x3cedbcb5,0xbc443d00,0x3cedbcb5,0x3cd5bcb5,0xbcfb3c44,0xbcd53cb5,0x3cfbbc44
.long 0xbd000000,0x3d000000,0xbd000000,0x3d000000,0x3cd53cb5,0xbcfbbc44,0xbcd5bcb5,0x3cfb3c44
.long 0xbc44bd00,0x3ced3cb5,0xbc44bd00,0x3ced3cb5,0xbbc83cb5,0xbcd5bced,0x3bc8bcb5,0x3cd53ced
.long 0x3cb50000,0x3cb53d00,0x3cb50000,0x3cb53d00,0xbcfbbcb5,0xbc8ebced,0x3cfb3cb5,0x3c8e3ced
.long 0x3ced3d00,0x3c443cb5,0x3ced3d00,0x3c443cb5,0xbc8ebcb5,0xbbc8bc44,0x3c8e3cb5,0x3bc83c44
.long 0x3cff3d00,0x3cf53cfb,0xbb490000,0xbc15bbc8,0x3cf53d00,0x3ca23cd5,0x3c150000,0x3cc63c8e
.long 0x3ce23d00,0x3b493c8e,0xbc710000,0xbcffbcd5,0x3cc63d00,0xbc713bc8,0x3ca20000,0x3ce23cfb
.long 0x3ca23d00,0xbce2bbc8,0xbcc60000,0xbc71bcfb,0x3c713d00,0xbcffbc8e,0x3ce20000,0xbb493cd5
.long 0x3c153d00,0xbcc6bcd5,0xbcf50000,0x3ca2bc8e,0x3b493d00,0xbc15bcfb,0x3cff0000,0xbcf53bc8
.long 0xbb493d00,0x3c15bcfb,0xbcff0000,0x3cf53bc8,0xbc153d00,0x3cc6bcd5,0x3cf50000,0xbca2bc8e
.long 0xbc713d00,0x3cffbc8e,0xbce20000,0x3b493cd5,0xbca23d00,0x3ce2bbc8,0x3cc60000,0x3c71bcfb
.long 0xbcc63d00,0x3c713bc8,0xbca20000,0xbce23cfb,0xbce23d00,0xbb493c8e,0x3c710000,0x3cffbcd5
.long 0xbcf53d00,0xbca23cd5,0xbc150000,0xbcc63c8e,0xbcff3d00,0xbcf53cfb,0x3b490000,0x3c15bbc8
.long 0x3ce23ced,0x3cc63cd5,0xbc71bc44,0xbca2bc8e,0x3b493c44,0xbc71bbc8,0x3cff3ced,0x3ce23cfb
.long 0xbcc6bc44,0xbcf5bcfb,0xbca2bced,0x3c15bbc8,0xbcf5bced,0x3b49bc8e,0xbc153c44,0xbcffbcd5
.long 0xbc15bced,0x3cff3c8e,0x3cf53c44,0x3b493cd5,0x3ca2bc44,0x3c153cfb,0xbcc6bced,0x3cf53bc8
.long 0x3cff3c44,0xbce23bc8,0xbb493ced,0xbc71bcfb,0x3c713ced,0xbca2bcd5,0x3ce2bc44,0xbcc63c8e
.long 0xbc713ced,0x3ca2bcd5,0xbce2bc44,0x3cc63c8e,0xbcff3c44,0x3ce23bc8,0x3b493ced,0x3c71bcfb
.long 0xbca2bc44,0xbc153cfb,0x3cc6bced,0xbcf53bc8,0x3c15bced,0xbcff3c8e,0xbcf53c44,0xbb493cd5
.long 0x3cf5bced,0xbb49bc8e,0x3c153c44,0x3cffbcd5,0x3cc6bc44,0x3cf5bcfb,0x3ca2bced,0xbc15bbc8
.long 0xbb493c44,0x3c71bbc8,0xbcff3ced,0xbce23cfb,0xbce23ced,0xbcc63cd5,0x3c71bc44,0x3ca2bc8e
.long 0x3ca23cb5,0x3c713c8e,0xbcc6bcb5,0xbce2bcd5,0xbce2bcb5,0xbcffbcfb,0x3c713cb5,0xbb493bc8
.long 0xbc15bcb5,0x3ca23bc8,0x3cf53cb5,0x3cc63cfb,0x3cff3cb5,0x3c153cd5,0xbb49bcb5,0x3cf53c8e
.long 0xbb493cb5,0xbcf5bcd5,0xbcffbcb5,0x3c15bc8e,0xbcf5bcb5,0x3cc6bbc8,0xbc153cb5,0xbca2bcfb
.long 0x3c71bcb5,0x3b493cfb,0x3ce23cb5,0xbcffbbc8,0x3cc63cb5,0xbce2bc8e,0x3ca2bcb5,0xbc713cd5
.long 0xbcc63cb5,0x3ce2bc8e,0xbca2bcb5,0x3c713cd5,0xbc71bcb5,0xbb493cfb,0xbce23cb5,0x3cffbbc8
.long 0x3cf5bcb5,0xbcc6bbc8,0x3c153cb5,0x3ca2bcfb,0x3b493cb5,0x3cf5bcd5,0x3cffbcb5,0xbc15bc8e
.long 0xbcff3cb5,0xbc153cd5,0x3b49bcb5,0xbcf53c8e,0x3c15bcb5,0xbca23bc8,0xbcf53cb5,0xbcc63cfb
.long 0x3ce2bcb5,0x3cffbcfb,0xbc713cb5,0x3b493bc8,0xbca23cb5,0xbc713c8e,0x3cc6bcb5,0x3ce2bcd5
.long 0x3c153c44,0x3b493bc8,0xbcf5bced,0xbcffbcfb,0xbcc6bced,0xbc15bc8e,0xbca2bc44,0xbcf5bcd5
.long 0x3cff3ced,0x3c713cd5,0xbb493c44,0xbce2bc8e,0xbce2bc44,0xbca2bcfb,0x3c713ced,0xbcc6bbc8
.long 0x3c71bc44,0x3cc63cfb,0x3ce23ced,0xbca23bc8,0x3b493ced,0xbce2bcd5,0x3cff3c44,0xbc713c8e
.long 0xbca2bced,0x3cf53c8e,0x3cc6bc44,0xbc153cd5,0x3cf53c44,0xbcffbbc8,0x3c15bced,0xbb493cfb
.long 0xbcf53c44,0x3cffbbc8,0xbc15bced,0x3b493cfb,0x3ca2bced,0xbcf53c8e,0xbcc6bc44,0x3c153cd5
.long 0xbb493ced,0x3ce2bcd5,0xbcff3c44,0x3c713c8e,0xbc71bc44,0xbcc63cfb,0xbce23ced,0x3ca23bc8
.long 0x3ce2bc44,0x3ca2bcfb,0xbc713ced,0x3cc6bbc8,0xbcff3ced,0xbc713cd5,0x3b493c44,0x3ce2bc8e
.long 0x3cc6bced,0x3c15bc8e,0x3ca2bc44,0x3cf5bcd5,0xbc153c44,0xbb493bc8,0x3cf5bced,0x3cffbcfb
.long 0xbcff3d00,0xbcf53cfb,0x3b490000,0x3c15bbc8,0xbcf53d00,0xbca23cd5,0xbc150000,0xbcc63c8e
.long 0xbce23d00,0xbb493c8e,0x3c710000,0x3cffbcd5,0xbcc63d00,0x3c713bc8,0xbca20000,0xbce23cfb
.long 0xbca23d00,0x3ce2bbc8,0x3cc60000,0x3c71bcfb,0xbc713d00,0x3cffbc8e,0xbce20000,0x3b493cd5
.long 0xbc153d00,0x3cc6bcd5,0x3cf50000,0xbca2bc8e,0xbb493d00,0x3c15bcfb,0xbcff0000,0x3cf53bc8
.long 0x3b493d00,0xbc15bcfb,0x3cff0000,0xbcf53bc8,0x3c153d00,0xbcc6bcd5,0xbcf50000,0x3ca2bc8e
.long 0x3c713d00,0xbcffbc8e,0x3ce20000,0xbb493cd5,0x3ca23d00,0xbce2bbc8,0xbcc60000,0xbc71bcfb
.long 0x3cc63d00,0xbc713bc8,0x3ca20000,0x3ce23cfb,0x3ce23d00,0x3b493c8e,0xbc710000,0xbcffbcd5
.long 0x3cf53d00,0x3ca23cd5,0x3c150000,0x3cc63c8e,0x3cff3d00,0x3cf53cfb,0xbb490000,0xbc15bbc8
.long 0xbce23ced,0xbcc63cd5,0x3c71bc44,0x3ca2bc8e,0xbb493c44,0x3c71bbc8,0xbcff3ced,0xbce23cfb
.long 0x3cc6bc44,0x3cf5bcfb,0x3ca2bced,0xbc15bbc8,0x3cf5bced,0xbb49bc8e,0x3c153c44,0x3cffbcd5
.long 0x3c15bced,0xbcff3c8e,0xbcf53c44,0xbb493cd5,0xbca2bc44,0xbc153cfb,0x3cc6bced,0xbcf53bc8
.long 0xbcff3c44,0x3ce23bc8,0x3b493ced,0x3c71bcfb,0xbc713ced,0x3ca2bcd5,0xbce2bc44,0x3cc63c8e
.long 0x3c713ced,0xbca2bcd5,0x3ce2bc44,0xbcc63c8e,0x3cff3c44,0xbce23bc8,0xbb493ced,0xbc71bcfb
.long 0x3ca2bc44,0x3c153cfb,0xbcc6bced,0x3cf53bc8,0xbc15bced,0x3cff3c8e,0x3cf53c44,0x3b493cd5
.long 0xbcf5bced,0x3b49bc8e,0xbc153c44,0xbcffbcd5,0xbcc6bc44,0xbcf5bcfb,0xbca2bced,0x3c15bbc8
.long 0x3b493c44,0xbc71bbc8,0x3cff3ced,0x3ce23cfb,0x3ce23ced,0x3cc63cd5,0xbc71bc44,0xbca2bc8e
.long 0xbca23cb5,0xbc713c8e,0x3cc6bcb5,0x3ce2bcd5,0x3ce2bcb5,0x3cffbcfb,0xbc713cb5,0x3b493bc8
.long 0x3c15bcb5,0xbca23bc8,0xbcf53cb5,0xbcc63cfb,0xbcff3cb5,0xbc153cd5,0x3b49bcb5,0xbcf53c8e
.long 0x3b493cb5,0x3cf5bcd5,0x3cffbcb5,0xbc15bc8e,0x3cf5bcb5,0xbcc6bbc8,0x3c153cb5,0x3ca2bcfb
.long 0xbc71bcb5,0xbb493cfb,0xbce23cb5,0x3cffbbc8,0xbcc63cb5,0x3ce2bc8e,0xbca2bcb5,0x3c713cd5
.long 0x3cc63cb5,0xbce2bc8e,0x3ca2bcb5,0xbc713cd5,0x3c71bcb5,0x3b493cfb,0x3ce23cb5,0xbcffbbc8
.long 0xbcf5bcb5,0x3cc6bbc8,0xbc153cb5,0xbca2bcfb,0xbb493cb5,0xbcf5bcd5,0xbcffbcb5,0x3c15bc8e
.long 0x3cff3cb5,0x3c153cd5,0xbb49bcb5,0x3cf53c8e,0xbc15bcb5,0x3ca23bc8,0x3cf53cb5,0x3cc63cfb
.long 0xbce2bcb5,0xbcffbcfb,0x3c713cb5,0xbb493bc8,0x3ca23cb5,0x3c713c8e,0xbcc6bcb5,0xbce2bcd5
.long 0xbc153c44,0xbb493bc8,0x3cf5bced,0x3cffbcfb,0x3cc6bced,0x3c15bc8e,0x3ca2bc44,0x3cf5bcd5
.long 0xbcff3ced,0xbc713cd5,0x3b493c44,0x3ce2bc8e,0x3ce2bc44,0x3ca2bcfb,0xbc713ced,0x3cc6bbc8
.long 0xbc71bc44,0xbcc63cfb,0xbce23ced,0x3ca23bc8,0xbb493ced,0x3ce2bcd5,0xbcff3c44,0x3c713c8e
.long 0x3ca2bced,0xbcf53c8e,0xbcc6bc44,0x3c153cd5,0xbcf53c44,0x3cffbbc8,0xbc15bced,0x3b493cfb
.long 0x3cf53c44,0xbcffbbc8,0x3c15bced,0xbb493cfb,0xbca2bced,0x3cf53c8e,0x3cc6bc44,0xbc153cd5
.long 0x3b493ced,0xbce2bcd5,0x3cff3c44,0xbc713c8e,0x3c71bc44,0x3cc63cfb,0x3ce23ced,0xbca23bc8
.long 0xbce2bc44,0xbca2bcfb,0x3c713ced,0xbcc6bbc8,0x3cff3ced,0x3c713cd5,0xbb493c44,0xbce2bc8e
.long 0xbcc6bced,0xbc15bc8e,0xbca2bc44,0xbcf5bcd5,0x3c153c44,0x3b493bc8,0xbcf5bced,0xbcffbcfb
.long 0x3b490000,0x3c153bc8,0x3cff3d00,0x3cf53cfb,0x3c150000,0x3cc63c8e,0xbcf5bd00,0xbca2bcd5
.long 0x3c710000,0x3cff3cd5,0x3ce23d00,0x3b493c8e,0x3ca20000,0x3ce23cfb,0xbcc6bd00,0x3c71bbc8
.long 0x3cc60000,0x3c713cfb,0x3ca23d00,0xbce2bbc8,0x3ce20000,0xbb493cd5,0xbc71bd00,0x3cff3c8e
.long 0x3cf50000,0xbca23c8e,0x3c153d00,0xbcc6bcd5,0x3cff0000,0xbcf53bc8,0xbb49bd00,0x3c153cfb
.long 0x3cff0000,0xbcf5bbc8,0xbb493d00,0x3c15bcfb,0x3cf50000,0xbca2bc8e,0x3c15bd00,0xbcc63cd5
.long 0x3ce20000,0xbb49bcd5,0xbc713d00,0x3cffbc8e,0x3cc60000,0x3c71bcfb,0x3ca2bd00,0xbce23bc8
.long 0x3ca20000,0x3ce2bcfb,0xbcc63d00,0x3c713bc8,0x3c710000,0x3cffbcd5,0x3ce2bd00,0x3b49bc8e
.long 0x3c150000,0x3cc6bc8e,0xbcf53d00,0xbca23cd5,0x3b490000,0x3c15bbc8,0x3cffbd00,0x3cf5bcfb
.long 0x3c713c44,0x3ca23c8e,0x3ce23ced,0x3cc63cd5,0x3cff3ced,0x3ce23cfb,0xbb49bc44,0x3c713bc8
.long 0x3ca23ced,0xbc153bc8,0xbcc6bc44,0xbcf5bcfb,0xbc153c44,0xbcffbcd5,0x3cf53ced,0xbb493c8e
.long 0xbcf5bc44,0xbb49bcd5,0xbc15bced,0x3cff3c8e,0xbcc6bced,0x3cf53bc8,0xbca23c44,0xbc15bcfb
.long 0x3b49bced,0x3c713cfb,0x3cff3c44,0xbce23bc8,0x3ce2bc44,0xbcc63c8e,0xbc71bced,0x3ca23cd5
.long 0x3ce23c44,0xbcc6bc8e,0xbc713ced,0x3ca2bcd5,0x3b493ced,0x3c71bcfb,0x3cffbc44,0xbce2bbc8
.long 0xbcc63ced,0x3cf5bbc8,0xbca2bc44,0xbc153cfb,0xbcf53c44,0xbb493cd5,0xbc153ced,0x3cffbc8e
.long 0xbc15bc44,0xbcff3cd5,0x3cf5bced,0xbb49bc8e,0x3ca2bced,0xbc15bbc8,0xbcc63c44,0xbcf53cfb
.long 0x3cffbced,0x3ce2bcfb,0xbb493c44,0x3c71bbc8,0x3c71bc44,0x3ca2bc8e,0x3ce2bced,0x3cc6bcd5
.long 0x3cc63cb5,0x3ce23cd5,0x3ca23cb5,0x3c713c8e,0x3c713cb5,0xbb493bc8,0x3ce23cb5,0x3cff3cfb
.long 0xbcf5bcb5,0xbcc6bcfb,0xbc15bcb5,0x3ca23bc8,0xbb49bcb5,0x3cf53c8e,0xbcffbcb5,0xbc15bcd5
.long 0x3cff3cb5,0xbc153c8e,0xbb493cb5,0xbcf5bcd5,0xbc153cb5,0xbca2bcfb,0x3cf53cb5,0xbcc63bc8
.long 0xbce2bcb5,0x3cff3bc8,0x3c71bcb5,0x3b493cfb,0x3ca2bcb5,0xbc713cd5,0xbcc6bcb5,0x3ce23c8e
.long 0x3ca23cb5,0xbc71bcd5,0xbcc63cb5,0x3ce2bc8e,0xbce23cb5,0x3cffbbc8,0x3c713cb5,0x3b49bcfb
.long 0xbc15bcb5,0xbca23cfb,0x3cf5bcb5,0xbcc6bbc8,0x3cffbcb5,0xbc15bc8e,0xbb49bcb5,0xbcf53cd5
.long 0xbb493cb5,0x3cf5bc8e,0xbcff3cb5,0xbc153cd5,0xbcf53cb5,0xbcc63cfb,0xbc153cb5,0x3ca2bbc8
.long 0x3c71bcb5,0xbb49bbc8,0x3ce2bcb5,0x3cffbcfb,0x3cc6bcb5,0x3ce2bcd5,0x3ca2bcb5,0x3c71bc8e
.long 0x3cf53ced,0x3cff3cfb,0x3c153c44,0x3b493bc8,0xbca2bc44,0xbcf5bcd5,0x3cc63ced,0x3c153c8e
.long 0x3b49bc44,0x3ce23c8e,0x3cff3ced,0x3c713cd5,0x3c713ced,0xbcc6bbc8,0x3ce23c44,0x3ca23cfb
.long 0xbce2bced,0x3ca2bbc8,0x3c71bc44,0x3cc63cfb,0x3cff3c44,0xbc713c8e,0xbb49bced,0x3ce23cd5
.long 0xbcc63c44,0x3c15bcd5,0xbca2bced,0x3cf53c8e,0x3c15bced,0xbb493cfb,0xbcf5bc44,0x3cff3bc8
.long 0x3c153ced,0xbb49bcfb,0xbcf53c44,0x3cffbbc8,0xbcc6bc44,0x3c153cd5,0xbca23ced,0x3cf5bc8e
.long 0x3cffbc44,0xbc71bc8e,0xbb493ced,0x3ce2bcd5,0xbce23ced,0x3ca23bc8,0x3c713c44,0x3cc6bcfb
.long 0x3c71bced,0xbcc63bc8,0x3ce2bc44,0x3ca2bcfb,0x3b493c44,0x3ce2bc8e,0x3cffbced,0x3c71bcd5
.long 0xbca23c44,0xbcf53cd5,0x3cc6bced,0x3c15bc8e,0x3cf5bced,0x3cffbcfb,0x3c15bc44,0x3b49bbc8
.long 0xbb490000,0xbc153bc8,0xbcff3d00,0xbcf53cfb,0xbc150000,0xbcc63c8e,0x3cf5bd00,0x3ca2bcd5
.long 0xbc710000,0xbcff3cd5,0xbce23d00,0xbb493c8e,0xbca20000,0xbce23cfb,0x3cc6bd00,0xbc71bbc8
.long 0xbcc60000,0xbc713cfb,0xbca23d00,0x3ce2bbc8,0xbce20000,0x3b493cd5,0x3c71bd00,0xbcff3c8e
.long 0xbcf50000,0x3ca23c8e,0xbc153d00,0x3cc6bcd5,0xbcff0000,0x3cf53bc8,0x3b49bd00,0xbc153cfb
.long 0xbcff0000,0x3cf5bbc8,0x3b493d00,0xbc15bcfb,0xbcf50000,0x3ca2bc8e,0xbc15bd00,0x3cc63cd5
.long 0xbce20000,0x3b49bcd5,0x3c713d00,0xbcffbc8e,0xbcc60000,0xbc71bcfb,0xbca2bd00,0x3ce23bc8
.long 0xbca20000,0xbce2bcfb,0x3cc63d00,0xbc713bc8,0xbc710000,0xbcffbcd5,0xbce2bd00,0xbb49bc8e
.long 0xbc150000,0xbcc6bc8e,0x3cf53d00,0x3ca23cd5,0xbb490000,0xbc15bbc8,0xbcffbd00,0xbcf5bcfb
.long 0xbc713c44,0xbca23c8e,0xbce23ced,0xbcc63cd5,0xbcff3ced,0xbce23cfb,0x3b49bc44,0xbc713bc8
.long 0xbca23ced,0x3c153bc8,0x3cc6bc44,0x3cf5bcfb,0x3c153c44,0x3cffbcd5,0xbcf53ced,0x3b493c8e
.long 0x3cf5bc44,0x3b49bcd5,0x3c15bced,0xbcff3c8e,0x3cc6bced,0xbcf53bc8,0x3ca23c44,0x3c15bcfb
.long 0xbb49bced,0xbc713cfb,0xbcff3c44,0x3ce23bc8,0xbce2bc44,0x3cc63c8e,0x3c71bced,0xbca23cd5
.long 0xbce23c44,0x3cc6bc8e,0x3c713ced,0xbca2bcd5,0xbb493ced,0xbc71bcfb,0xbcffbc44,0x3ce2bbc8
.long 0x3cc63ced,0xbcf5bbc8,0x3ca2bc44,0x3c153cfb,0x3cf53c44,0x3b493cd5,0x3c153ced,0xbcffbc8e
.long 0x3c15bc44,0x3cff3cd5,0xbcf5bced,0x3b49bc8e,0xbca2bced,0x3c15bbc8,0x3cc63c44,0x3cf53cfb
.long 0xbcffbced,0xbce2bcfb,0x3b493c44,0xbc71bbc8,0xbc71bc44,0xbca2bc8e,0xbce2bced,0xbcc6bcd5
.long 0xbcc63cb5,0xbce23cd5,0xbca23cb5,0xbc713c8e,0xbc713cb5,0x3b493bc8,0xbce23cb5,0xbcff3cfb
.long 0x3cf5bcb5,0x3cc6bcfb,0x3c15bcb5,0xbca23bc8,0x3b49bcb5,0xbcf53c8e,0x3cffbcb5,0x3c15bcd5
.long 0xbcff3cb5,0x3c153c8e,0x3b493cb5,0x3cf5bcd5,0x3c153cb5,0x3ca2bcfb,0xbcf53cb5,0x3cc63bc8
.long 0x3ce2bcb5,0xbcff3bc8,0xbc71bcb5,0xbb493cfb,0xbca2bcb5,0x3c713cd5,0x3cc6bcb5,0xbce23c8e
.long 0xbca23cb5,0x3c71bcd5,0x3cc63cb5,0xbce2bc8e,0x3ce23cb5,0xbcffbbc8,0xbc713cb5,0xbb49bcfb
.long 0x3c15bcb5,0x3ca23cfb,0xbcf5bcb5,0x3cc6bbc8,0xbcffbcb5,0x3c15bc8e,0x3b49bcb5,0x3cf53cd5
.long 0x3b493cb5,0xbcf5bc8e,0x3cff3cb5,0x3c153cd5,0x3cf53cb5,0x3cc63cfb,0x3c153cb5,0xbca2bbc8
.long 0xbc71bcb5,0x3b49bbc8,0xbce2bcb5,0xbcffbcfb,0xbcc6bcb5,0xbce2bcd5,0xbca2bcb5,0xbc71bc8e
.long 0xbcf53ced,0xbcff3cfb,0xbc153c44,0xbb493bc8,0x3ca2bc44,0x3cf5bcd5,0xbcc63ced,0xbc153c8e
.long 0xbb49bc44,0xbce23c8e,0xbcff3ced,0xbc713cd5,0xbc713ced,0x3cc6bbc8,0xbce23c44,0xbca23cfb
.long 0x3ce2bced,0xbca2bbc8,0xbc71bc44,0xbcc63cfb,0xbcff3c44,0x3c713c8e,0x3b49bced,0xbce23cd5
.long 0x3cc63c44,0xbc15bcd5,0x3ca2bced,0xbcf53c8e,0xbc15bced,0x3b493cfb,0x3cf5bc44,0xbcff3bc8
.long 0xbc153ced,0x3b49bcfb,0x3cf53c44,0xbcffbbc8,0x3cc6bc44,0xbc153cd5,0x3ca23ced,0xbcf5bc8e
.long 0xbcffbc44,0x3c71bc8e,0x3b493ced,0xbce2bcd5,0x3ce23ced,0xbca23bc8,0xbc713c44,0xbcc6bcfb
.long 0xbc71bced,0x3cc63bc8,0xbce2bc44,0xbca2bcfb,0xbb493c44,0xbce2bc8e,0xbcffbced,0xbc71bcd5
.long 0x3ca23c44,0x3cf53cd5,0xbcc6bced,0xbc15bc8e,0xbcf5bced,0xbcffbcfb,0xbc15bc44,0xbb49bbc8
.long 0x3d003d00,0x3d003d00,0x3d003d00,0x3d003d00,0x3cf53cff,0x3cc63ce2,0xbcf5bcff,0xbcc6bce2
.long 0x3cd53cfb,0x3bc83c8e,0x3cd53cfb,0x3bc83c8e,0x3ca23cf5,0xbc713b49,0xbca2bcf5,0x3c71bb49
.long 0x3c443ced,0xbcedbc44,0x3c443ced,0xbcedbc44,0x3b493ce2,0xbcf5bcc6,0xbb49bce2,0x3cf53cc6
.long 0xbbc83cd5,0xbc8ebcfb,0xbbc83cd5,0xbc8ebcfb,0xbc713cc6,0x3b49bcf5,0x3c71bcc6,0xbb493cf5
.long 0xbcb53cb5,0x3cb5bcb5,0xbcb53cb5,0x3cb5bcb5,0xbce23ca2,0x3cffbc15,0x3ce2bca2,0xbcff3c15
.long 0xbcfb3c8e,0x3cd53bc8,0xbcfb3c8e,0x3cd53bc8,0xbcff3c71,0x3c153ca2,0x3cffbc71,0xbc15bca2
.long 0xbced3c44,0xbc443ced,0xbced3c44,0xbc443ced,0xbcc63c15,0xbce23cff,0x3cc6bc15,0x3ce2bcff
.long 0xbc8e3bc8,0xbcfb3cd5,0xbc8e3bc8,0xbcfb3cd5,0xbc153b49,0xbca23c71,0x3c15bb49,0x3ca2bc71
.long 0x3d003d00,0x3d003d00,0x3d003d00,0x3d003d00,0x3c713ca2,0x3b493c15,0xbc71bca2,0xbb49bc15
.long 0xbc8ebbc8,0xbcfbbcd5,0xbc8ebbc8,0xbcfbbcd5,0xbcffbce2,0xbc15bcc6,0x3cff3ce2,0x3c153cc6
.long 0xbc44bced,0x3ced3c44,0xbc44bced,0x3ced3c44,0x3ca2bc15,0x3c713cff,0xbca23c15,0xbc71bcff
.long 0x3cfb3c8e,0xbcd53bc8,0x3cfb3c8e,0xbcd53bc8,0x3c153cff,0xbca2bce2,0xbc15bcff,0x3ca23ce2
.long 0xbcb53cb5,0x3cb5bcb5,0xbcb53cb5,0x3cb5bcb5,0xbcf5bb49,0x3cc63c71,0x3cf53b49,0xbcc6bc71
.long 0xbbc8bcd5,0xbc8e3cfb,0xbbc8bcd5,0xbc8e3cfb,0x3cc6bcf5,0xbce23b49,0xbcc63cf5,0x3ce2bb49
.long 0x3cedbc44,0x3c44bced,0x3cedbc44,0x3c44bced,0x3b493c71,0x3cf5bca2,0xbb49bc71,0xbcf53ca2
.long 0xbcd53cfb,0xbbc83c8e,0xbcd53cfb,0xbbc83c8e,0xbce23cc6,0xbcff3cf5,0x3ce2bcc6,0x3cffbcf5
.long 0x3d003d00,0x3d003d00,0x3d003d00,0x3d003d00,0xbc15bb49,0xbca2bc71,0x3c153b49,0x3ca23c71
.long 0xbcd5bcfb,0xbbc8bc8e,0xbcd5bcfb,0xbbc8bc8e,0x3cc63c15,0x3ce23cff,0xbcc6bc15,0xbce2bcff
.long 0x3c443ced,0xbcedbc44,0x3c443ced,0xbcedbc44,0xbcffbc71,0x3c15bca2,0x3cff3c71,0xbc153ca2
.long 0x3bc8bcd5,0x3c8e3cfb,0x3bc8bcd5,0x3c8e3cfb,0x3ce23ca2,0xbcffbc15,0xbce2bca2,0x3cff3c15
.long 0xbcb53cb5,0x3cb5bcb5,0xbcb53cb5,0x3cb5bcb5,0xbc71bcc6,0x3b493cf5,0x3c713cc6,0xbb49bcf5
.long 0x3cfbbc8e,0xbcd5bbc8,0x3cfbbc8e,0xbcd5bbc8,0xbb493ce2,0x3cf5bcc6,0x3b49bce2,0xbcf53cc6
.long 0xbced3c44,0xbc443ced,0xbced3c44,0xbc443ced,0x3ca2bcf5,0xbc71bb49,0xbca23cf5,0x3c713b49
.long 0x3c8ebbc8,0x3cfbbcd5,0x3c8ebbc8,0x3cfbbcd5,0xbcf53cff,0xbcc63ce2,0x3cf5bcff,0x3cc6bce2
.long 0x3d003d00,0x3d003d00,0x3d003d00,0x3d003d00,0xbce2bcc6,0xbcffbcf5,0x3ce23cc6,0x3cff3cf5
.long 0x3c8e3bc8,0x3cfb3cd5,0x3c8e3bc8,0x3cfb3cd5,0xbb493c71,0xbcf5bca2,0x3b49bc71,0x3cf53ca2
.long 0xbc44bced,0x3ced3c44,0xbc44bced,0x3ced3c44,0x3cc63cf5,0xbce2bb49,0xbcc6bcf5,0x3ce23b49
.long 0xbcfbbc8e,0x3cd5bbc8,0xbcfbbc8e,0x3cd5bbc8,0x3cf5bb49,0xbcc63c71,0xbcf53b49,0x3cc6bc71
.long 0xbcb53cb5,0x3cb5bcb5,0xbcb53cb5,0x3cb5bcb5,0x3c15bcff,0xbca23ce2,0xbc153cff,0x3ca2bce2
.long 0x3bc83cd5,0x3c8ebcfb,0x3bc83cd5,0x3c8ebcfb,0xbca2bc15,0xbc713cff,0x3ca23c15,0x3c71bcff
.long 0x3cedbc44,0x3c44bced,0x3cedbc44,0x3c44bced,0xbcff3ce2,0xbc153cc6,0x3cffbce2,0x3c15bcc6
.long 0x3cd5bcfb,0x3bc8bc8e,0x3cd5bcfb,0x3bc8bc8e,0xbc713ca2,0xbb493c15,0x3c71bca2,0x3b49bc15
.long 0x0,0x0,0x0,0x0,0x3c15bb49,0x3ca2bc71,0xbc153b49,0xbca23c71
.long 0x3c8ebbc8,0x3cfbbcd5,0x3c8ebbc8,0x3cfbbcd5,0x3cc6bc15,0x3ce2bcff,0xbcc63c15,0xbce23cff
.long 0x3cedbc44,0x3c44bced,0x3cedbc44,0x3c44bced,0x3cffbc71,0xbc15bca2,0xbcff3c71,0x3c153ca2
.long 0x3cfbbc8e,0xbcd5bbc8,0x3cfbbc8e,0xbcd5bbc8,0x3ce2bca2,0xbcff3c15,0xbce23ca2,0x3cffbc15
.long 0x3cb5bcb5,0xbcb53cb5,0x3cb5bcb5,0xbcb53cb5,0x3c71bcc6,0xbb493cf5,0xbc713cc6,0x3b49bcf5
.long 0x3bc8bcd5,0x3c8e3cfb,0x3bc8bcd5,0x3c8e3cfb,0xbb49bce2,0x3cf53cc6,0x3b493ce2,0xbcf5bcc6
.long 0xbc44bced,0x3ced3c44,0xbc44bced,0x3ced3c44,0xbca2bcf5,0x3c71bb49,0x3ca23cf5,0xbc713b49
.long 0xbcd5bcfb,0xbbc8bc8e,0xbcd5bcfb,0xbbc8bc8e,0xbcf5bcff,0xbcc6bce2,0x3cf53cff,0x3cc63ce2
.long 0x0,0x0,0x0,0x0,0x3ce2bcc6,0x3cffbcf5,0xbce23cc6,0xbcff3cf5
.long 0x3cd5bcfb,0x3bc8bc8e,0x3cd5bcfb,0x3bc8bc8e,0xbb49bc71,0xbcf53ca2,0x3b493c71,0x3cf5bca2
.long 0xbced3c44,0xbc443ced,0xbced3c44,0xbc443ced,0xbcc63cf5,0x3ce2bb49,0x3cc6bcf5,0xbce23b49
.long 0x3bc83cd5,0x3c8ebcfb,0x3bc83cd5,0x3c8ebcfb,0x3cf53b49,0xbcc6bc71,0xbcf5bb49,0x3cc63c71
.long 0x3cb5bcb5,0xbcb53cb5,0x3cb5bcb5,0xbcb53cb5,0xbc15bcff,0x3ca23ce2,0x3c153cff,0xbca2bce2
.long 0xbcfbbc8e,0x3cd5bbc8,0xbcfbbc8e,0x3cd5bbc8,0xbca23c15,0xbc71bcff,0x3ca2bc15,0x3c713cff
.long 0x3c443ced,0xbcedbc44,0x3c443ced,0xbcedbc44,0x3cff3ce2,0x3c153cc6,0xbcffbce2,0xbc15bcc6
.long 0x3c8e3bc8,0x3cfb3cd5,0x3c8e3bc8,0x3cfb3cd5,0xbc71bca2,0xbb49bc15,0x3c713ca2,0x3b493c15
.long 0x0,0x0,0x0,0x0,0x3cf5bcff,0x3cc6bce2,0xbcf53cff,0xbcc63ce2
.long 0xbc8e3bc8,0xbcfb3cd5,0xbc8e3bc8,0xbcfb3cd5,0xbca23cf5,0x3c713b49,0x3ca2bcf5,0xbc71bb49
.long 0x3cedbc44,0x3c44bced,0x3cedbc44,0x3c44bced,0x3b49bce2,0xbcf53cc6,0xbb493ce2,0x3cf5bcc6
.long 0xbcfb3c8e,0x3cd53bc8,0xbcfb3c8e,0x3cd53bc8,0x3c713cc6,0xbb49bcf5,0xbc71bcc6,0x3b493cf5
.long 0x3cb5bcb5,0xbcb53cb5,0x3cb5bcb5,0xbcb53cb5,0xbce2bca2,0x3cff3c15,0x3ce23ca2,0xbcffbc15
.long 0xbbc83cd5,0xbc8ebcfb,0xbbc83cd5,0xbc8ebcfb,0x3cff3c71,0xbc153ca2,0xbcffbc71,0x3c15bca2
.long 0xbc44bced,0x3ced3c44,0xbc44bced,0x3ced3c44,0xbcc6bc15,0xbce2bcff,0x3cc63c15,0x3ce23cff
.long 0x3cd53cfb,0x3bc83c8e,0x3cd53cfb,0x3bc83c8e,0x3c153b49,0x3ca23c71,0xbc15bb49,0xbca2bc71
.long 0x0,0x0,0x0,0x0,0x3c71bca2,0x3b49bc15,0xbc713ca2,0xbb493c15
.long 0xbcd53cfb,0xbbc83c8e,0xbcd53cfb,0xbbc83c8e,0x3cffbce2,0x3c15bcc6,0xbcff3ce2,0xbc153cc6
.long 0xbced3c44,0xbc443ced,0xbced3c44,0xbc443ced,0x3ca23c15,0x3c71bcff,0xbca2bc15,0xbc713cff
.long 0xbbc8bcd5,0xbc8e3cfb,0xbbc8bcd5,0xbc8e3cfb,0xbc153cff,0x3ca2bce2,0x3c15bcff,0xbca23ce2
.long 0x3cb5bcb5,0xbcb53cb5,0x3cb5bcb5,0xbcb53cb5,0xbcf53b49,0x3cc6bc71,0x3cf5bb49,0xbcc63c71
.long 0x3cfb3c8e,0xbcd53bc8,0x3cfb3c8e,0xbcd53bc8,0xbcc6bcf5,0x3ce23b49,0x3cc63cf5,0xbce2bb49
.long 0x3c443ced,0xbcedbc44,0x3c443ced,0xbcedbc44,0x3b49bc71,0x3cf53ca2,0xbb493c71,0xbcf5bca2
.long 0xbc8ebbc8,0xbcfbbcd5,0xbc8ebbc8,0xbcfbbcd5,0x3ce23cc6,0x3cff3cf5,0xbce2bcc6,0xbcffbcf5
.long 0x0,0x0,0x0,0x0,0x3c153b49,0x3ca23c71,0xbc15bb49,0xbca2bc71
.long 0x3c8e3bc8,0x3cfb3cd5,0x3c8e3bc8,0x3cfb3cd5,0x3cc63c15,0x3ce23cff,0xbcc6bc15,0xbce2bcff
.long 0x3ced3c44,0x3c443ced,0x3ced3c44,0x3c443ced,0x3cff3c71,0xbc153ca2,0xbcffbc71,0x3c15bca2
.long 0x3cfb3c8e,0xbcd53bc8,0x3cfb3c8e,0xbcd53bc8,0x3ce23ca2,0xbcffbc15,0xbce2bca2,0x3cff3c15
.long 0x3cb53cb5,0xbcb5bcb5,0x3cb53cb5,0xbcb5bcb5,0x3c713cc6,0xbb49bcf5,0xbc71bcc6,0x3b493cf5
.long 0x3bc83cd5,0x3c8ebcfb,0x3bc83cd5,0x3c8ebcfb,0xbb493ce2,0x3cf5bcc6,0x3b49bce2,0xbcf53cc6
.long 0xbc443ced,0x3cedbc44,0xbc443ced,0x3cedbc44,0xbca23cf5,0x3c713b49,0x3ca2bcf5,0xbc71bb49
.long 0xbcd53cfb,0xbbc83c8e,0xbcd53cfb,0xbbc83c8e,0xbcf53cff,0xbcc63ce2,0x3cf5bcff,0x3cc6bce2
.long 0x0,0x0,0x0,0x0,0x3ce23cc6,0x3cff3cf5,0xbce2bcc6,0xbcffbcf5
.long 0x3cd53cfb,0x3bc83c8e,0x3cd53cfb,0x3bc83c8e,0xbb493c71,0xbcf5bca2,0x3b49bc71,0x3cf53ca2
.long 0xbcedbc44,0xbc44bced,0xbcedbc44,0xbc44bced,0xbcc6bcf5,0x3ce23b49,0x3cc63cf5,0xbce2bb49
.long 0x3bc8bcd5,0x3c8e3cfb,0x3bc8bcd5,0x3c8e3cfb,0x3cf5bb49,0xbcc63c71,0xbcf53b49,0x3cc6bc71
.long 0x3cb53cb5,0xbcb5bcb5,0x3cb53cb5,0xbcb5bcb5,0xbc153cff,0x3ca2bce2,0x3c15bcff,0xbca23ce2
.long 0xbcfb3c8e,0x3cd53bc8,0xbcfb3c8e,0x3cd53bc8,0xbca2bc15,0xbc713cff,0x3ca23c15,0x3c71bcff
.long 0x3c44bced,0xbced3c44,0x3c44bced,0xbced3c44,0x3cffbce2,0x3c15bcc6,0xbcff3ce2,0xbc153cc6
.long 0x3c8ebbc8,0x3cfbbcd5,0x3c8ebbc8,0x3cfbbcd5,0xbc713ca2,0xbb493c15,0x3c71bca2,0x3b49bc15
.long 0x0,0x0,0x0,0x0,0x3cf53cff,0x3cc63ce2,0xbcf5bcff,0xbcc6bce2
.long 0xbc8ebbc8,0xbcfbbcd5,0xbc8ebbc8,0xbcfbbcd5,0xbca2bcf5,0x3c71bb49,0x3ca23cf5,0xbc713b49
.long 0x3ced3c44,0x3c443ced,0x3ced3c44,0x3c443ced,0x3b493ce2,0xbcf5bcc6,0xbb49bce2,0x3cf53cc6
.long 0xbcfbbc8e,0x3cd5bbc8,0xbcfbbc8e,0x3cd5bbc8,0x3c71bcc6,0xbb493cf5,0xbc713cc6,0x3b49bcf5
.long 0x3cb53cb5,0xbcb5bcb5,0x3cb53cb5,0xbcb5bcb5,0xbce23ca2,0x3cffbc15,0x3ce2bca2,0xbcff3c15
.long 0xbbc8bcd5,0xbc8e3cfb,0xbbc8bcd5,0xbc8e3cfb,0x3cffbc71,0xbc15bca2,0xbcff3c71,0x3c153ca2
.long 0xbc443ced,0x3cedbc44,0xbc443ced,0x3cedbc44,0xbcc63c15,0xbce23cff,0x3cc6bc15,0x3ce2bcff
.long 0x3cd5bcfb,0x3bc8bc8e,0x3cd5bcfb,0x3bc8bc8e,0x3c15bb49,0x3ca2bc71,0xbc153b49,0xbca23c71
.long 0x0,0x0,0x0,0x0,0x3c713ca2,0x3b493c15,0xbc71bca2,0xbb49bc15
.long 0xbcd5bcfb,0xbbc8bc8e,0xbcd5bcfb,0xbbc8bc8e,0x3cff3ce2,0x3c153cc6,0xbcffbce2,0xbc15bcc6
.long 0xbcedbc44,0xbc44bced,0xbcedbc44,0xbc44bced,0x3ca2bc15,0x3c713cff,0xbca23c15,0xbc71bcff
.long 0xbbc83cd5,0xbc8ebcfb,0xbbc83cd5,0xbc8ebcfb,0xbc15bcff,0x3ca23ce2,0x3c153cff,0xbca2bce2
.long 0x3cb53cb5,0xbcb5bcb5,0x3cb53cb5,0xbcb5bcb5,0xbcf5bb49,0x3cc63c71,0x3cf53b49,0xbcc6bc71
.long 0x3cfbbc8e,0xbcd5bbc8,0x3cfbbc8e,0xbcd5bbc8,0xbcc63cf5,0x3ce2bb49,0x3cc6bcf5,0xbce23b49
.long 0x3c44bced,0xbced3c44,0x3c44bced,0xbced3c44,0x3b493c71,0x3cf5bca2,0xbb49bc71,0xbcf53ca2
.long 0xbc8e3bc8,0xbcfb3cd5,0xbc8e3bc8,0xbcfb3cd5,0x3ce2bcc6,0x3cffbcf5,0xbce23cc6,0xbcff3cf5
.long 0xbd003d00,0xbd003d00,0xbd003d00,0xbd003d00,0xbcf53cff,0xbcc63ce2,0x3cf5bcff,0x3cc6bce2
.long 0xbcd53cfb,0xbbc83c8e,0xbcd53cfb,0xbbc83c8e,0xbca23cf5,0x3c713b49,0x3ca2bcf5,0xbc71bb49
.long 0xbc443ced,0x3cedbc44,0xbc443ced,0x3cedbc44,0xbb493ce2,0x3cf5bcc6,0x3b49bce2,0xbcf53cc6
.long 0x3bc83cd5,0x3c8ebcfb,0x3bc83cd5,0x3c8ebcfb,0x3c713cc6,0xbb49bcf5,0xbc71bcc6,0x3b493cf5
.long 0x3cb53cb5,0xbcb5bcb5,0x3cb53cb5,0xbcb5bcb5,0x3ce23ca2,0xbcffbc15,0xbce2bca2,0x3cff3c15
.long 0x3cfb3c8e,0xbcd53bc8,0x3cfb3c8e,0xbcd53bc8,0x3cff3c71,0xbc153ca2,0xbcffbc71,0x3c15bca2
.long 0x3ced3c44,0x3c443ced,0x3ced3c44,0x3c443ced,0x3cc63c15,0x3ce23cff,0xbcc6bc15,0xbce2bcff
.long 0x3c8e3bc8,0x3cfb3cd5,0x3c8e3bc8,0x3cfb3cd5,0x3c153b49,0x3ca23c71,0xbc15bb49,0xbca2bc71
.long 0xbd003d00,0xbd003d00,0xbd003d00,0xbd003d00,0xbc713ca2,0xbb493c15,0x3c71bca2,0x3b49bc15
.long 0x3c8ebbc8,0x3cfbbcd5,0x3c8ebbc8,0x3cfbbcd5,0x3cffbce2,0x3c15bcc6,0xbcff3ce2,0xbc153cc6
.long 0x3c44bced,0xbced3c44,0x3c44bced,0xbced3c44,0xbca2bc15,0xbc713cff,0x3ca23c15,0x3c71bcff
.long 0xbcfb3c8e,0x3cd53bc8,0xbcfb3c8e,0x3cd53bc8,0xbc153cff,0x3ca2bce2,0x3c15bcff,0xbca23ce2
.long 0x3cb53cb5,0xbcb5bcb5,0x3cb53cb5,0xbcb5bcb5,0x3cf5bb49,0xbcc63c71,0xbcf53b49,0x3cc6bc71
.long 0x3bc8bcd5,0x3c8e3cfb,0x3bc8bcd5,0x3c8e3cfb,0xbcc6bcf5,0x3ce23b49,0x3cc63cf5,0xbce2bb49
.long 0xbcedbc44,0xbc44bced,0xbcedbc44,0xbc44bced,0xbb493c71,0xbcf5bca2,0x3b49bc71,0x3cf53ca2
.long 0x3cd53cfb,0x3bc83c8e,0x3cd53cfb,0x3bc83c8e,0x3ce23cc6,0x3cff3cf5,0xbce2bcc6,0xbcffbcf5
.long 0xbd003d00,0xbd003d00,0xbd003d00,0xbd003d00,0x3c15bb49,0x3ca2bc71,0xbc153b49,0xbca23c71
.long 0x3cd5bcfb,0x3bc8bc8e,0x3cd5bcfb,0x3bc8bc8e,0xbcc63c15,0xbce23cff,0x3cc6bc15,0x3ce2bcff
.long 0xbc443ced,0x3cedbc44,0xbc443ced,0x3cedbc44,0x3cffbc71,0xbc15bca2,0xbcff3c71,0x3c153ca2
.long 0xbbc8bcd5,0xbc8e3cfb,0xbbc8bcd5,0xbc8e3cfb,0xbce23ca2,0x3cffbc15,0x3ce2bca2,0xbcff3c15
.long 0x3cb53cb5,0xbcb5bcb5,0x3cb53cb5,0xbcb5bcb5,0x3c71bcc6,0xbb493cf5,0xbc713cc6,0x3b49bcf5
.long 0xbcfbbc8e,0x3cd5bbc8,0xbcfbbc8e,0x3cd5bbc8,0x3b493ce2,0xbcf5bcc6,0xbb49bce2,0x3cf53cc6
.long 0x3ced3c44,0x3c443ced,0x3ced3c44,0x3c443ced,0xbca2bcf5,0x3c71bb49,0x3ca23cf5,0xbc713b49
.long 0xbc8ebbc8,0xbcfbbcd5,0xbc8ebbc8,0xbcfbbcd5,0x3cf53cff,0x3cc63ce2,0xbcf5bcff,0xbcc6bce2
.long 0xbd003d00,0xbd003d00,0xbd003d00,0xbd003d00,0x3ce2bcc6,0x3cffbcf5,0xbce23cc6,0xbcff3cf5
.long 0xbc8e3bc8,0xbcfb3cd5,0xbc8e3bc8,0xbcfb3cd5,0x3b493c71,0x3cf5bca2,0xbb49bc71,0xbcf53ca2
.long 0x3c44bced,0xbced3c44,0x3c44bced,0xbced3c44,0xbcc63cf5,0x3ce2bb49,0x3cc6bcf5,0xbce23b49
.long 0x3cfbbc8e,0xbcd5bbc8,0x3cfbbc8e,0xbcd5bbc8,0xbcf5bb49,0x3cc63c71,0x3cf53b49,0xbcc6bc71
.long 0x3cb53cb5,0xbcb5bcb5,0x3cb53cb5,0xbcb5bcb5,0xbc15bcff,0x3ca23ce2,0x3c153cff,0xbca2bce2
.long 0xbbc83cd5,0xbc8ebcfb,0xbbc83cd5,0xbc8ebcfb,0x3ca2bc15,0x3c713cff,0xbca23c15,0xbc71bcff
.long 0xbcedbc44,0xbc44bced,0xbcedbc44,0xbc44bced,0x3cff3ce2,0x3c153cc6,0xbcffbce2,0xbc15bcc6
.long 0xbcd5bcfb,0xbbc8bc8e,0xbcd5bcfb,0xbbc8bc8e,0x3c713ca2,0x3b493c15,0xbc71bca2,0xbb49bc15
.long 0x3d803d80,0x3d803d80,0x3d803d80,0x3d803d80,0x3d7b3d80,0x3d553d6d,0xbd7bbd80,0xbd55bd6d
.long 0x3d6d3d80,0x3cc43d35,0x3d6d3d80,0x3cc43d35,0x3d553d80,0xbc483cc4,0xbd55bd80,0x3c48bcc4
.long 0x3d353d80,0xbd350000,0x3d353d80,0xbd350000,0x3d0e3d80,0xbd7bbcc4,0xbd0ebd80,0x3d7b3cc4
.long 0x3cc43d80,0xbd6dbd35,0x3cc43d80,0xbd6dbd35,0x3c483d80,0xbd0ebd6d,0xbc48bd80,0x3d0e3d6d
.long 0x3d80,0xbd80,0x3d80,0xbd80,0xbc483d80,0x3d0ebd6d,0x3c48bd80,0xbd0e3d6d
.long 0xbcc43d80,0x3d6dbd35,0xbcc43d80,0x3d6dbd35,0xbd0e3d80,0x3d7bbcc4,0x3d0ebd80,0xbd7b3cc4
.long 0xbd353d80,0x3d350000,0xbd353d80,0x3d350000,0xbd553d80,0x3c483cc4,0x3d55bd80,0xbc48bcc4
.long 0xbd6d3d80,0xbcc43d35,0xbd6d3d80,0xbcc43d35,0xbd7b3d80,0xbd553d6d,0x3d7bbd80,0x3d55bd6d
.long 0x3d803d80,0x3d803d80,0x3d803d80,0x3d803d80,0x3d0e3d35,0x3c483cc4,0xbd0ebd35,0xbc48bcc4
.long 0xbcc40000,0xbd6dbd35,0xbcc40000,0xbd6dbd35,0xbd7bbd35,0xbd0ebd6d,0x3d7b3d35,0x3d0e3d6d
.long 0xbd35bd80,0x3d350000,0xbd35bd80,0x3d350000,0x3c48bd35,0x3d553d6d,0xbc483d35,0xbd55bd6d
.long 0x3d6d0000,0xbcc43d35,0x3d6d0000,0xbcc43d35,0x3d553d35,0xbd7bbcc4,0xbd55bd35,0x3d7b3cc4
.long 0x3d80,0xbd80,0x3d80,0xbd80,0xbd553d35,0x3d7bbcc4,0x3d55bd35,0xbd7b3cc4
.long 0xbd6d0000,0x3cc43d35,0xbd6d0000,0x3cc43d35,0xbc48bd35,0xbd553d6d,0x3c483d35,0x3d55bd6d
.long 0x3d35bd80,0xbd350000,0x3d35bd80,0xbd350000,0x3d7bbd35,0x3d0ebd6d,0xbd7b3d35,0xbd0e3d6d
.long 0x3cc40000,0x3d6dbd35,0x3cc40000,0x3d6dbd35,0xbd0e3d35,0xbc483cc4,0x3d0ebd35,0x3c48bcc4
.long 0x3d803d80,0x3d803d80,0x3d803d80,0x3d803d80,0xbc480000,0xbd0ebcc4,0x3c480000,0x3d0e3cc4
.long 0xbd6dbd80,0xbcc4bd35,0xbd6dbd80,0xbcc4bd35,0x3d0e0000,0x3d7b3d6d,0xbd0e0000,0xbd7bbd6d
.long 0x3d353d80,0xbd350000,0x3d353d80,0xbd350000,0xbd550000,0xbc48bd6d,0x3d550000,0x3c483d6d
.long 0xbcc4bd80,0x3d6d3d35,0xbcc4bd80,0x3d6d3d35,0x3d7b0000,0xbd553cc4,0xbd7b0000,0x3d55bcc4
.long 0x3d80,0xbd80,0x3d80,0xbd80,0xbd7b0000,0x3d553cc4,0x3d7b0000,0xbd55bcc4
.long 0x3cc4bd80,0xbd6d3d35,0x3cc4bd80,0xbd6d3d35,0x3d550000,0x3c48bd6d,0xbd550000,0xbc483d6d
.long 0xbd353d80,0x3d350000,0xbd353d80,0x3d350000,0xbd0e0000,0xbd7b3d6d,0x3d0e0000,0x3d7bbd6d
.long 0x3d6dbd80,0x3cc4bd35,0x3d6dbd80,0x3cc4bd35,0x3c480000,0x3d0ebcc4,0xbc480000,0xbd0e3cc4
.long 0x3d803d80,0x3d803d80,0x3d803d80,0x3d803d80,0xbd55bd35,0xbd7bbd6d,0x3d553d35,0x3d7b3d6d
.long 0x3cc40000,0x3d6d3d35,0x3cc40000,0x3d6d3d35,0x3c483d35,0xbd55bcc4,0xbc48bd35,0x3d553cc4
.long 0xbd35bd80,0x3d350000,0xbd35bd80,0x3d350000,0x3d7b3d35,0xbd0e3cc4,0xbd7bbd35,0x3d0ebcc4
.long 0xbd6d0000,0x3cc4bd35,0xbd6d0000,0x3cc4bd35,0x3d0ebd35,0xbc483d6d,0xbd0e3d35,0x3c48bd6d
.long 0x3d80,0xbd80,0x3d80,0xbd80,0xbd0ebd35,0x3c483d6d,0x3d0e3d35,0xbc48bd6d
.long 0x3d6d0000,0xbcc4bd35,0x3d6d0000,0xbcc4bd35,0xbd7b3d35,0x3d0e3cc4,0x3d7bbd35,0xbd0ebcc4
.long 0x3d35bd80,0xbd350000,0x3d35bd80,0xbd350000,0xbc483d35,0x3d55bcc4,0x3c48bd35,0xbd553cc4
.long 0xbcc40000,0xbd6d3d35,0xbcc40000,0xbd6d3d35,0x3d55bd35,0x3d7bbd6d,0xbd553d35,0xbd7b3d6d
.long 0xbd803d80,0xbd803d80,0xbd803d80,0xbd803d80,0xbd7b3d80,0xbd553d6d,0x3d7bbd80,0x3d55bd6d
.long 0xbd6d3d80,0xbcc43d35,0xbd6d3d80,0xbcc43d35,0xbd553d80,0x3c483cc4,0x3d55bd80,0xbc48bcc4
.long 0xbd353d80,0x3d350000,0xbd353d80,0x3d350000,0xbd0e3d80,0x3d7bbcc4,0x3d0ebd80,0xbd7b3cc4
.long 0xbcc43d80,0x3d6dbd35,0xbcc43d80,0x3d6dbd35,0xbc483d80,0x3d0ebd6d,0x3c48bd80,0xbd0e3d6d
.long 0x3d80,0xbd80,0x3d80,0xbd80,0x3c483d80,0xbd0ebd6d,0xbc48bd80,0x3d0e3d6d
.long 0x3cc43d80,0xbd6dbd35,0x3cc43d80,0xbd6dbd35,0x3d0e3d80,0xbd7bbcc4,0xbd0ebd80,0x3d7b3cc4
.long 0x3d353d80,0xbd350000,0x3d353d80,0xbd350000,0x3d553d80,0xbc483cc4,0xbd55bd80,0x3c48bcc4
.long 0x3d6d3d80,0x3cc43d35,0x3d6d3d80,0x3cc43d35,0x3d7b3d80,0x3d553d6d,0xbd7bbd80,0xbd55bd6d
.long 0xbd803d80,0xbd803d80,0xbd803d80,0xbd803d80,0xbd0e3d35,0xbc483cc4,0x3d0ebd35,0x3c48bcc4
.long 0x3cc40000,0x3d6dbd35,0x3cc40000,0x3d6dbd35,0x3d7bbd35,0x3d0ebd6d,0xbd7b3d35,0xbd0e3d6d
.long 0x3d35bd80,0xbd350000,0x3d35bd80,0xbd350000,0xbc48bd35,0xbd553d6d,0x3c483d35,0x3d55bd6d
.long 0xbd6d0000,0x3cc43d35,0xbd6d0000,0x3cc43d35,0xbd553d35,0x3d7bbcc4,0x3d55bd35,0xbd7b3cc4
.long 0x3d80,0xbd80,0x3d80,0xbd80,0x3d553d35,0xbd7bbcc4,0xbd55bd35,0x3d7b3cc4
.long 0x3d6d0000,0xbcc43d35,0x3d6d0000,0xbcc43d35,0x3c48bd35,0x3d553d6d,0xbc483d35,0xbd55bd6d
.long 0xbd35bd80,0x3d350000,0xbd35bd80,0x3d350000,0xbd7bbd35,0xbd0ebd6d,0x3d7b3d35,0x3d0e3d6d
.long 0xbcc40000,0xbd6dbd35,0xbcc40000,0xbd6dbd35,0x3d0e3d35,0x3c483cc4,0xbd0ebd35,0xbc48bcc4
.long 0xbd803d80,0xbd803d80,0xbd803d80,0xbd803d80,0x3c480000,0x3d0ebcc4,0xbc480000,0xbd0e3cc4
.long 0x3d6dbd80,0x3cc4bd35,0x3d6dbd80,0x3cc4bd35,0xbd0e0000,0xbd7b3d6d,0x3d0e0000,0x3d7bbd6d
.long 0xbd353d80,0x3d350000,0xbd353d80,0x3d350000,0x3d550000,0x3c48bd6d,0xbd550000,0xbc483d6d
.long 0x3cc4bd80,0xbd6d3d35,0x3cc4bd80,0xbd6d3d35,0xbd7b0000,0x3d553cc4,0x3d7b0000,0xbd55bcc4
.long 0x3d80,0xbd80,0x3d80,0xbd80,0x3d7b0000,0xbd553cc4,0xbd7b0000,0x3d55bcc4
.long 0xbcc4bd80,0x3d6d3d35,0xbcc4bd80,0x3d6d3d35,0xbd550000,0xbc48bd6d,0x3d550000,0x3c483d6d
.long 0x3d353d80,0xbd350000,0x3d353d80,0xbd350000,0x3d0e0000,0x3d7b3d6d,0xbd0e0000,0xbd7bbd6d
.long 0xbd6dbd80,0xbcc4bd35,0xbd6dbd80,0xbcc4bd35,0xbc480000,0xbd0ebcc4,0x3c480000,0x3d0e3cc4
.long 0xbd803d80,0xbd803d80,0xbd803d80,0xbd803d80,0x3d55bd35,0x3d7bbd6d,0xbd553d35,0xbd7b3d6d
.long 0xbcc40000,0xbd6d3d35,0xbcc40000,0xbd6d3d35,0xbc483d35,0x3d55bcc4,0x3c48bd35,0xbd553cc4
.long 0x3d35bd80,0xbd350000,0x3d35bd80,0xbd350000,0xbd7b3d35,0x3d0e3cc4,0x3d7bbd35,0xbd0ebcc4
.long 0x3d6d0000,0xbcc4bd35,0x3d6d0000,0xbcc4bd35,0xbd0ebd35,0x3c483d6d,0x3d0e3d35,0xbc48bd6d
.long 0x3d80,0xbd80,0x3d80,0xbd80,0x3d0ebd35,0xbc483d6d,0xbd0e3d35,0x3c48bd6d
.long 0xbd6d0000,0x3cc4bd35,0xbd6d0000,0x3cc4bd35,0x3d7b3d35,0xbd0e3cc4,0xbd7bbd35,0x3d0ebcc4
.long 0xbd35bd80,0x3d350000,0xbd35bd80,0x3d350000,0x3c483d35,0xbd55bcc4,0xbc48bd35,0x3d553cc4
.long 0x3cc40000,0x3d6d3d35,0x3cc40000,0x3d6d3d35,0xbd55bd35,0xbd7bbd6d,0x3d553d35,0x3d7b3d6d
.long 0x0,0x0,0x0,0x0,0x3c480000,0x3d0e3cc4,0xbc480000,0xbd0ebcc4
.long 0x3cc40000,0x3d6d3d35,0x3cc40000,0x3d6d3d35,0x3d0e0000,0x3d7b3d6d,0xbd0e0000,0xbd7bbd6d
.long 0x3d350000,0x3d353d80,0x3d350000,0x3d353d80,0x3d550000,0x3c483d6d,0xbd550000,0xbc48bd6d
.long 0x3d6d0000,0xbcc43d35,0x3d6d0000,0xbcc43d35,0x3d7b0000,0xbd553cc4,0xbd7b0000,0x3d55bcc4
.long 0x3d800000,0xbd800000,0x3d800000,0xbd800000,0x3d7b0000,0xbd55bcc4,0xbd7b0000,0x3d553cc4
.long 0x3d6d0000,0xbcc4bd35,0x3d6d0000,0xbcc4bd35,0x3d550000,0x3c48bd6d,0xbd550000,0xbc483d6d
.long 0x3d350000,0x3d35bd80,0x3d350000,0x3d35bd80,0x3d0e0000,0x3d7bbd6d,0xbd0e0000,0xbd7b3d6d
.long 0x3cc40000,0x3d6dbd35,0x3cc40000,0x3d6dbd35,0x3c480000,0x3d0ebcc4,0xbc480000,0xbd0e3cc4
.long 0x0,0x0,0x0,0x0,0x3d553d35,0x3d7b3d6d,0xbd55bd35,0xbd7bbd6d
.long 0x3d6d3d80,0x3cc43d35,0x3d6d3d80,0x3cc43d35,0x3c483d35,0xbd55bcc4,0xbc48bd35,0x3d553cc4
.long 0xbd350000,0xbd35bd80,0xbd350000,0xbd35bd80,0xbd7bbd35,0x3d0ebcc4,0x3d7b3d35,0xbd0e3cc4
.long 0xbcc4bd80,0x3d6d3d35,0xbcc4bd80,0x3d6d3d35,0x3d0ebd35,0xbc483d6d,0xbd0e3d35,0x3c48bd6d
.long 0x3d800000,0xbd800000,0x3d800000,0xbd800000,0x3d0e3d35,0xbc48bd6d,0xbd0ebd35,0x3c483d6d
.long 0xbcc43d80,0x3d6dbd35,0xbcc43d80,0x3d6dbd35,0xbd7b3d35,0x3d0e3cc4,0x3d7bbd35,0xbd0ebcc4
.long 0xbd350000,0xbd353d80,0xbd350000,0xbd353d80,0x3c48bd35,0xbd553cc4,0xbc483d35,0x3d55bcc4
.long 0x3d6dbd80,0x3cc4bd35,0x3d6dbd80,0x3cc4bd35,0x3d55bd35,0x3d7bbd6d,0xbd553d35,0xbd7b3d6d
.long 0x0,0x0,0x0,0x0,0x3d7b3d80,0x3d553d6d,0xbd7bbd80,0xbd55bd6d
.long 0xbcc40000,0xbd6dbd35,0xbcc40000,0xbd6dbd35,0xbd55bd80,0x3c48bcc4,0x3d553d80,0xbc483cc4
.long 0x3d350000,0x3d353d80,0x3d350000,0x3d353d80,0x3d0e3d80,0xbd7bbcc4,0xbd0ebd80,0x3d7b3cc4
.long 0xbd6d0000,0x3cc4bd35,0xbd6d0000,0x3cc4bd35,0xbc48bd80,0x3d0e3d6d,0x3c483d80,0xbd0ebd6d
.long 0x3d800000,0xbd800000,0x3d800000,0xbd800000,0xbc483d80,0x3d0ebd6d,0x3c48bd80,0xbd0e3d6d
.long 0xbd6d0000,0x3cc43d35,0xbd6d0000,0x3cc43d35,0x3d0ebd80,0xbd7b3cc4,0xbd0e3d80,0x3d7bbcc4
.long 0x3d350000,0x3d35bd80,0x3d350000,0x3d35bd80,0xbd553d80,0x3c483cc4,0x3d55bd80,0xbc48bcc4
.long 0xbcc40000,0xbd6d3d35,0xbcc40000,0xbd6d3d35,0x3d7bbd80,0x3d55bd6d,0xbd7b3d80,0xbd553d6d
.long 0x0,0x0,0x0,0x0,0x3d0e3d35,0x3c483cc4,0xbd0ebd35,0xbc48bcc4
.long 0xbd6dbd80,0xbcc4bd35,0xbd6dbd80,0xbcc4bd35,0x3d7b3d35,0x3d0e3d6d,0xbd7bbd35,0xbd0ebd6d
.long 0xbd350000,0xbd35bd80,0xbd350000,0xbd35bd80,0x3c48bd35,0x3d553d6d,0xbc483d35,0xbd55bd6d
.long 0x3cc43d80,0xbd6dbd35,0x3cc43d80,0xbd6dbd35,0xbd55bd35,0x3d7b3cc4,0x3d553d35,0xbd7bbcc4
.long 0x3d800000,0xbd800000,0x3d800000,0xbd800000,0xbd553d35,0x3d7bbcc4,0x3d55bd35,0xbd7b3cc4
.long 0x3cc4bd80,0xbd6d3d35,0x3cc4bd80,0xbd6d3d35,0x3c483d35,0x3d55bd6d,0xbc48bd35,0xbd553d6d
.long 0xbd350000,0xbd353d80,0xbd350000,0xbd353d80,0x3d7bbd35,0x3d0ebd6d,0xbd7b3d35,0xbd0e3d6d
.long 0xbd6d3d80,0xbcc43d35,0xbd6d3d80,0xbcc43d35,0x3d0ebd35,0x3c48bcc4,0xbd0e3d35,0xbc483cc4
.long 0x0,0x0,0x0,0x0,0xbc480000,0xbd0e3cc4,0x3c480000,0x3d0ebcc4
.long 0xbcc40000,0xbd6d3d35,0xbcc40000,0xbd6d3d35,0xbd0e0000,0xbd7b3d6d,0x3d0e0000,0x3d7bbd6d
.long 0xbd350000,0xbd353d80,0xbd350000,0xbd353d80,0xbd550000,0xbc483d6d,0x3d550000,0x3c48bd6d
.long 0xbd6d0000,0x3cc43d35,0xbd6d0000,0x3cc43d35,0xbd7b0000,0x3d553cc4,0x3d7b0000,0xbd55bcc4
.long 0xbd800000,0x3d800000,0xbd800000,0x3d800000,0xbd7b0000,0x3d55bcc4,0x3d7b0000,0xbd553cc4
.long 0xbd6d0000,0x3cc4bd35,0xbd6d0000,0x3cc4bd35,0xbd550000,0xbc48bd6d,0x3d550000,0x3c483d6d
.long 0xbd350000,0xbd35bd80,0xbd350000,0xbd35bd80,0xbd0e0000,0xbd7bbd6d,0x3d0e0000,0x3d7b3d6d
.long 0xbcc40000,0xbd6dbd35,0xbcc40000,0xbd6dbd35,0xbc480000,0xbd0ebcc4,0x3c480000,0x3d0e3cc4
.long 0x0,0x0,0x0,0x0,0xbd553d35,0xbd7b3d6d,0x3d55bd35,0x3d7bbd6d
.long 0xbd6d3d80,0xbcc43d35,0xbd6d3d80,0xbcc43d35,0xbc483d35,0x3d55bcc4,0x3c48bd35,0xbd553cc4
.long 0x3d350000,0x3d35bd80,0x3d350000,0x3d35bd80,0x3d7bbd35,0xbd0ebcc4,0xbd7b3d35,0x3d0e3cc4
.long 0x3cc4bd80,0xbd6d3d35,0x3cc4bd80,0xbd6d3d35,0xbd0ebd35,0x3c483d6d,0x3d0e3d35,0xbc48bd6d
.long 0xbd800000,0x3d800000,0xbd800000,0x3d800000,0xbd0e3d35,0x3c48bd6d,0x3d0ebd35,0xbc483d6d
.long 0x3cc43d80,0xbd6dbd35,0x3cc43d80,0xbd6dbd35,0x3d7b3d35,0xbd0e3cc4,0xbd7bbd35,0x3d0ebcc4
.long 0x3d350000,0x3d353d80,0x3d350000,0x3d353d80,0xbc48bd35,0x3d553cc4,0x3c483d35,0xbd55bcc4
.long 0xbd6dbd80,0xbcc4bd35,0xbd6dbd80,0xbcc4bd35,0xbd55bd35,0xbd7bbd6d,0x3d553d35,0x3d7b3d6d
.long 0x0,0x0,0x0,0x0,0xbd7b3d80,0xbd553d6d,0x3d7bbd80,0x3d55bd6d
.long 0x3cc40000,0x3d6dbd35,0x3cc40000,0x3d6dbd35,0x3d55bd80,0xbc48bcc4,0xbd553d80,0x3c483cc4
.long 0xbd350000,0xbd353d80,0xbd350000,0xbd353d80,0xbd0e3d80,0x3d7bbcc4,0x3d0ebd80,0xbd7b3cc4
.long 0x3d6d0000,0xbcc4bd35,0x3d6d0000,0xbcc4bd35,0x3c48bd80,0xbd0e3d6d,0xbc483d80,0x3d0ebd6d
.long 0xbd800000,0x3d800000,0xbd800000,0x3d800000,0x3c483d80,0xbd0ebd6d,0xbc48bd80,0x3d0e3d6d
.long 0x3d6d0000,0xbcc43d35,0x3d6d0000,0xbcc43d35,0xbd0ebd80,0x3d7b3cc4,0x3d0e3d80,0xbd7bbcc4
.long 0xbd350000,0xbd35bd80,0xbd350000,0xbd35bd80,0x3d553d80,0xbc483cc4,0xbd55bd80,0x3c48bcc4
.long 0x3cc40000,0x3d6d3d35,0x3cc40000,0x3d6d3d35,0xbd7bbd80,0xbd55bd6d,0x3d7b3d80,0x3d553d6d
.long 0x0,0x0,0x0,0x0,0xbd0e3d35,0xbc483cc4,0x3d0ebd35,0x3c48bcc4
.long 0x3d6dbd80,0x3cc4bd35,0x3d6dbd80,0x3cc4bd35,0xbd7b3d35,0xbd0e3d6d,0x3d7bbd35,0x3d0ebd6d
.long 0x3d350000,0x3d35bd80,0x3d350000,0x3d35bd80,0xbc48bd35,0xbd553d6d,0x3c483d35,0x3d55bd6d
.long 0xbcc43d80,0x3d6dbd35,0xbcc43d80,0x3d6dbd35,0x3d55bd35,0xbd7b3cc4,0xbd553d35,0x3d7bbcc4
.long 0xbd800000,0x3d800000,0xbd800000,0x3d800000,0x3d553d35,0xbd7bbcc4,0xbd55bd35,0x3d7b3cc4
.long 0xbcc4bd80,0x3d6d3d35,0xbcc4bd80,0x3d6d3d35,0xbc483d35,0xbd55bd6d,0x3c48bd35,0x3d553d6d
.long 0x3d350000,0x3d353d80,0x3d350000,0x3d353d80,0xbd7bbd35,0xbd0ebd6d,0x3d7b3d35,0x3d0e3d6d
.long 0x3d6d3d80,0x3cc43d35,0x3d6d3d80,0x3cc43d35,0xbd0ebd35,0xbc48bcc4,0x3d0e3d35,0x3c483cc4
.size CTAB, 16384
```
